```python
import torch

def _softmax(x, axis=-1):
    return torch.softmax(x, dim=axis)
def _gelu(x):
    return torch.nn.functional.gelu(x, approximate="tanh")
def _silu(x):
    return torch.nn.functional.silu(x)
def _sigmoid(x):
    return torch.sigmoid(x)
def _layernorm(x, axis=-1, eps=1e-5):
    m = x.mean(dim=axis, keepdim=True)
    v = x.var(dim=axis, keepdim=True, unbiased=False)
    return (x - m) / torch.sqrt(v + eps)
def _scatter_add(tgt, idx, src, axis=0):
    return tgt.clone().index_add_(axis, idx, src)
def _segment_sum(src, seg, n):
    out = torch.zeros((n,) + src.shape[1:], dtype=src.dtype)
    return out.index_add_(0, seg, src)
def _pad(x, pw):
    flat = tuple(v for pair in reversed(pw) for v in pair)
    return torch.nn.functional.pad(x, flat)

kernel_name = 'recurrent_scan__mha_block_cached__mixer_channel_mlp__decode'

def setup_inputs():

    _w = (lambda a: (lambda t: t.to(torch.bfloat16) if t.is_floating_point() else t)(torch.as_tensor(a)))
    def _A_setup():
        B, Sq, D = 4, 1, 512
        H, Sk, Dh = 32, 4096, 128
        return {
            "x": _w((lambda *s: torch.randn(*s, dtype=torch.bfloat16) * 0.1)(B, Sq, D)),
            "k_cache": _w((lambda *s: torch.randn(*s, dtype=torch.bfloat16) * 0.8)(B, H, Sk, Dh)),
            "v_cache": _w((lambda *s: torch.randn(*s, dtype=torch.bfloat16) * 3.2)(B, H, Sk, Dh)),
            "wq": _w((lambda *s: torch.randn(*s, dtype=torch.bfloat16) * 0.8)(D, H * Dh) * (D ** -0.5)),
            "wo": _w((lambda *s: torch.randn(*s, dtype=torch.bfloat16) * 3.2)(H * Dh, D) * ((H * Dh) ** -0.5)),
        }
    _A_in = _A_setup()

    def _B_setup():
        B, S, D, F = 4, 1, 512, 1792
        return {
            "x": _w((lambda *s: torch.randn(*s, dtype=torch.bfloat16) * 0.1)(B, S, D)),
            "w1": _w((lambda *s: torch.randn(*s, dtype=torch.bfloat16) * 3.2)(D, F) * (D ** -0.5)),
            "b1": _w((lambda *s: torch.randn(*s, dtype=torch.bfloat16) * 3.2)(F)),
            "w2": _w((lambda *s: torch.randn(*s, dtype=torch.bfloat16) * 3.2)(F, D) * (F ** -0.5)),
            "b2": _w((lambda *s: torch.randn(*s, dtype=torch.bfloat16) * 3.2)(D)),
        }
    _B_in = _B_setup()

    return {
        "A_x": _A_in["x"],
        "A_k_cache": _A_in["k_cache"],
        "A_v_cache": _A_in["v_cache"],
        "A_wq": _A_in["wq"],
        "A_wo": _A_in["wo"],
        "B_x": _B_in["x"],
        "B_w1": _B_in["w1"],
        "B_b1": _B_in["b1"],
        "B_w2": _B_in["w2"],
        "B_b2": _B_in["b2"],
    }

def reference(A_x, A_k_cache, A_v_cache, A_wq, A_wo, B_x, B_w1, B_b1, B_w2, B_b2):
    def _A_ref(x, k_cache, v_cache, wq, wo):
        B, Sq, D = x.shape
        H, Dh = 32, 128
        q = (lambda x, *d: x.permute(*d))((x @ wq).reshape(B, Sq, H, Dh), 0, 2, 1, 3)
        scores = torch.einsum("bhqd,bhkd->bhqk", q, k_cache) * (Dh ** -0.5)
        p = _softmax(scores, axis=-1)
        o = torch.einsum("bhqk,bhkd->bhqd", p, v_cache)
        return (lambda x, *d: x.permute(*d))(o, 0, 2, 1, 3).reshape(B, Sq, H * Dh) @ wo

    def _B_ref(x, w1, b1, w2, b2):
        y = _layernorm(x, axis=-1)
        h = _gelu(torch.einsum("bsd,df->bsf", y, w1) + b1)
        return torch.einsum("bsf,fd->bsd", h, w2) + b2

    x = A_x
    xn = _layernorm(x, axis=-1)
    s = _A_ref(xn, A_k_cache, A_v_cache, A_wq, A_wo)
    g = _silu(_B_ref(xn, B_w1, B_b1, B_w2, B_b2))
    return x + s * g
```

```asm
; @launch grid=(256,1,1) block=(512,1,1) lds=13312
.amdgcn_target "amdgcn-amd-amdhsa--gfx950"
.text
.globl recurrent_scan__mha_block_cached__mixer_channel_mlp__decode_kernel
.p2align 8
.type recurrent_scan__mha_block_cached__mixer_channel_mlp__decode_kernel,@function
recurrent_scan__mha_block_cached__mixer_channel_mlp__decode_kernel:
  s_load_dwordx16 s[16:31], s[0:1], 0
  s_load_dwordx8 s[32:39], s[0:1], 64
  s_load_dwordx2 s[40:41], s[0:1], 96
  s_cmp_ge_u32 s2, 256
  s_cbranch_scc1 L_end
  v_lshrrev_b32 v1, 6, v0
  v_and_b32 v2, 15, v0
  v_readfirstlane_b32 s3, v1
  s_bfe_u32 s5, s2, 0x10002
  s_and_b32 s59, s2, 0xc0
  s_and_b32 s4, s2, 3
  s_xor_b32 s4, s4, s5
  s_lshl4_add_u32 s59, s4, s59
  s_bfe_u32 s4, s2, 0x30003
  s_lshl1_add_u32 s59, s4, s59
  s_lshl_b32 s7, s59, 19
  s_or_b32 s59, s59, s5
  s_cmp_ge_u32 s3, 4
  s_cbranch_scc1 L_helper
  s_mov_b32 s10, 0x100000
  s_mov_b32 s11, 0x20000
  v_and_b32 v3, 0x2f, v0
  v_and_b32 v4, 0x50, v0
  v_and_b32 v5, 0x80, v0
  s_mul_i32 s50, s5, 0xe0000
  s_bitcmp1_b32 s59, 1
  s_cselect_b32 s6, 0x44400, 0
  s_xor_b32 s50, s50, s6
  s_bitcmp1_b32 s59, 2
  s_cselect_b32 s6, 0x8100, 0
  s_xor_b32 s50, s50, s6
  s_bitcmp1_b32 s59, 3
  s_cselect_b32 s6, 0xe4c00, 0
  s_xor_b32 s50, s50, s6
  s_bitcmp1_b32 s59, 4
  s_cselect_b32 s6, 0x28100, 0
  s_xor_b32 s50, s50, s6
  s_bitcmp1_b32 s59, 5
  s_cselect_b32 s6, 0xf4c00, 0
  s_xor_b32 s50, s50, s6
  s_bitcmp1_b32 s59, 7
  s_cselect_b32 s6, 0x400, 0
  s_xor_b32 s50, s50, s6
  v_lshlrev_b32 v3, 4, v3
  v_lshl_or_b32 v3, v4, 9, v3
  v_lshl_or_b32 v3, v5, 5, v3
  v_xor_b32 v5, s50, v3
  s_waitcnt lgkmcnt(0)
  s_add_u32 s8, s18, s7
  s_addc_u32 s9, s19, 0
  buffer_load_dwordx4 v[64:67], v5, s[8:11], 0 offen nt
  v_xor_b32 v4, 0x8100, v5
  buffer_load_dwordx4 v[68:71], v4, s[8:11], 0 offen nt
  s_branch L_s2
L_pf:
  s_lshr_b32 s50, s2, 3
  s_lshl1_add_u32 s50, s50, s3
  s_sub_u32 s50, s50, 6
  s_and_b32 s42, s2, 6
  s_mov_b32 s15, 0x20000
  s_bitcmp1_b32 s2, 0
  s_cbranch_scc0 L_pf2
  v_bfe_u32 v3, v0, 4, 2
  v_lshlrev_b32 v5, 4, v2
  v_lshl_or_b32 v5, v3, 14, v5
  s_lshl_b32 s50, s50, 9
  s_add_u32 s50, s50, s42
  s_lshl_b32 s50, s50, 7
  s_mov_b32 s14, 0x400000
  s_movk_i32 s51, 0x400
  s_mov_b32 s54, 15
  s_waitcnt lgkmcnt(0)
  s_mov_b64 s[12:13], s[24:25]
  s_branch L_pf3
L_pf2:
  v_and_b32 v5, 7, v0
  v_bfe_u32 v12, v0, 3, 3
  v_lshlrev_b32 v5, 4, v5
  v_lshl_or_b32 v5, v12, 9, v5
  s_mulk_i32 s50, 448
  s_add_u32 s50, s50, s42
  s_lshl_b32 s50, s50, 6
  s_mov_b32 s14, 1835008
  s_movk_i32 s51, 0x1000
  s_mov_b32 s54, 6
  s_waitcnt lgkmcnt(0)
  s_mov_b64 s[12:13], s[32:33]
L_pf3:
L_pf4:
  buffer_load_dwordx4 v[192:195], v5, s[12:15], s50 offen
  s_add_u32 s50, s50, s51
  s_sub_u32 s54, s54, 1
  s_cbranch_scc0 L_pf4
  s_barrier
  s_branch L_nofront
L_s2:
  s_barrier
  v_xor_b32 v4, 0x84c00, v5
  buffer_load_dwordx4 v[72:75], v4, s[8:11], 0 offen nt
  v_xor_b32 v4, 0x8cd00, v5
  buffer_load_dwordx4 v[76:79], v4, s[8:11], 0 offen nt
  v_xor_b32 v4, 0x400, v5
  buffer_load_dwordx4 v[80:83], v4, s[8:11], 0 offen nt
  v_xor_b32 v4, 0x8500, v5
  buffer_load_dwordx4 v[84:87], v4, s[8:11], 0 offen nt
  v_lshlrev_b32 v7, 4, v2
  v_lshrrev_b32 v6, 4, v0
  s_mov_b32 s14, s10
  s_mov_b32 s15, s11
  s_mov_b32 s46, s10
  s_mov_b32 s47, s11
  s_add_u32 s12, s20, s7
  s_addc_u32 s13, s21, 0
  s_mov_b32 s52, 0xaaaaaaaa
  s_mov_b32 s53, 0xaaaaaaaa
  s_mov_b32 s56, 0xcccccccc
  s_mov_b32 s57, 0xcccccccc
  s_lshr_b32 s60, s2, 3
  s_and_b32 s60, s60, 3
  s_add_u32 s60, s60, 3
  s_and_b32 s42, s2, 0x81
  s_cmp_eq_u32 s42, 0x81
  s_cselect_b32 s94, 1, 0
  s_cselect_b64 vcc, -1, 0
  s_cselect_b32 s60, s60, 0
  v_mov_b32 v21, 0
  v_mov_b32 v62, 0
  v_xor_b32 v4, 0x84800, v5
  s_waitcnt vmcnt(5)
  buffer_load_dwordx4 v[88:91], v4, s[8:11], 0 offen nt
  v_xor_b32 v4, 0x8c900, v5
  s_waitcnt vmcnt(5)
  buffer_load_dwordx4 v[92:95], v4, s[8:11], 0 offen nt
  v_xor_b32 v4, 0xd4c00, v5
  s_waitcnt vmcnt(5)
  buffer_load_dwordx4 v[96:99], v4, s[8:11], 0 offen nt
  v_xor_b32 v4, 0xdcd00, v5
  s_waitcnt vmcnt(5)
  buffer_load_dwordx4 v[100:103], v4, s[8:11], 0 offen nt
  v_xor_b32 v4, 0x50000, v5
  s_waitcnt vmcnt(5)
  buffer_load_dwordx4 v[104:107], v4, s[8:11], 0 offen nt
  v_xor_b32 v4, 0x58100, v5
  s_waitcnt vmcnt(5)
  buffer_load_dwordx4 v[108:111], v4, s[8:11], 0 offen nt
  v_xor_b32 v4, 0xd4800, v5
  s_waitcnt vmcnt(5)
  buffer_load_dwordx4 v[112:115], v4, s[8:11], 0 offen nt
  v_xor_b32 v4, 0xdc900, v5
  s_waitcnt vmcnt(5)
  buffer_load_dwordx4 v[116:119], v4, s[8:11], 0 offen nt
  v_xor_b32 v4, 0x50400, v5
  s_waitcnt vmcnt(5)
  buffer_load_dwordx4 v[120:123], v4, s[8:11], 0 offen nt
  v_xor_b32 v4, 0x58500, v5
  s_waitcnt vmcnt(5)
  buffer_load_dwordx4 v[124:127], v4, s[8:11], 0 offen nt
  v_xor_b32 v4, 0x40000, v5
  s_waitcnt vmcnt(5)
  buffer_load_dwordx4 v[128:131], v4, s[8:11], 0 offen nt
  v_xor_b32 v4, 0x48100, v5
  s_waitcnt vmcnt(5)
  buffer_load_dwordx4 v[132:135], v4, s[8:11], 0 offen nt
  v_xor_b32 v4, 0xc4c00, v5
  s_waitcnt vmcnt(5)
  buffer_load_dwordx4 v[136:139], v4, s[8:11], 0 offen nt
  v_xor_b32 v4, 0xccd00, v5
  s_waitcnt vmcnt(5)
  buffer_load_dwordx4 v[140:143], v4, s[8:11], 0 offen nt
  v_xor_b32 v4, 0x40400, v5
  s_waitcnt vmcnt(5)
  buffer_load_dwordx4 v[144:147], v4, s[8:11], 0 offen nt
  v_xor_b32 v4, 0x48500, v5
  s_waitcnt vmcnt(5)
  buffer_load_dwordx4 v[148:151], v4, s[8:11], 0 offen nt
  v_xor_b32 v4, 0xc4800, v5
  s_waitcnt vmcnt(5)
  buffer_load_dwordx4 v[152:155], v4, s[8:11], 0 offen nt
  v_xor_b32 v4, 0xcc900, v5
  s_waitcnt vmcnt(5)
  buffer_load_dwordx4 v[156:159], v4, s[8:11], 0 offen nt
  v_xor_b32 v4, 0x94c00, v5
  s_waitcnt vmcnt(5)
  buffer_load_dwordx4 v[160:163], v4, s[8:11], 0 offen nt
  v_xor_b32 v4, 0x9cd00, v5
  s_waitcnt vmcnt(5)
  buffer_load_dwordx4 v[164:167], v4, s[8:11], 0 offen nt
  v_xor_b32 v4, 0x10000, v5
  s_waitcnt vmcnt(5)
  buffer_load_dwordx4 v[168:171], v4, s[8:11], 0 offen nt
  v_xor_b32 v4, 0x18100, v5
  s_waitcnt vmcnt(5)
  buffer_load_dwordx4 v[172:175], v4, s[8:11], 0 offen nt
  v_xor_b32 v4, 0x94800, v5
  s_waitcnt vmcnt(5)
  buffer_load_dwordx4 v[176:179], v4, s[8:11], 0 offen nt
  v_xor_b32 v4, 0x9c900, v5
  s_waitcnt vmcnt(5)
  buffer_load_dwordx4 v[180:183], v4, s[8:11], 0 offen nt
  v_xor_b32 v4, 0x10400, v5
  s_waitcnt vmcnt(5)
  buffer_load_dwordx4 v[184:187], v4, s[8:11], 0 offen nt
  v_xor_b32 v4, 0x18500, v5
  s_waitcnt vmcnt(5)
  buffer_load_dwordx4 v[188:191], v4, s[8:11], 0 offen nt
  s_barrier
L_walk:
  ds_read_b128 v[8:11], v7 offset:8192
  s_waitcnt lgkmcnt(0)
  s_waitcnt vmcnt(30)
  v_dot2_f32_bf16 v24, v64, v8, 0
  v_dot2_f32_bf16 v25, v68, v8, 0
  v_dot2_f32_bf16 v24, v65, v9, v24
  v_dot2_f32_bf16 v25, v69, v9, v25
  v_dot2_f32_bf16 v24, v66, v10, v24
  v_dot2_f32_bf16 v25, v70, v10, v25
  v_dot2_f32_bf16 v24, v67, v11, v24
  v_dot2_f32_bf16 v25, v71, v11, v25
  v_xor_b32 v4, 0x20c00, v5
  buffer_load_dwordx4 v[64:67], v4, s[8:11], 0 offen nt
  v_xor_b32 v4, 0x28d00, v5
  buffer_load_dwordx4 v[68:71], v4, s[8:11], 0 offen nt
  s_waitcnt vmcnt(30)
  v_dot2_f32_bf16 v26, v72, v8, 0
  v_dot2_f32_bf16 v27, v76, v8, 0
  v_dot2_f32_bf16 v26, v73, v9, v26
  v_dot2_f32_bf16 v27, v77, v9, v27
  v_dot2_f32_bf16 v26, v74, v10, v26
  v_dot2_f32_bf16 v27, v78, v10, v27
  v_dot2_f32_bf16 v26, v75, v11, v26
  v_dot2_f32_bf16 v27, v79, v11, v27
  v_xor_b32 v4, 0xa4000, v5
  buffer_load_dwordx4 v[72:75], v4, s[8:11], 0 offen nt
  v_xor_b32 v4, 0xac100, v5
  buffer_load_dwordx4 v[76:79], v4, s[8:11], 0 offen nt
  s_waitcnt vmcnt(30)
  v_dot2_f32_bf16 v28, v80, v8, 0
  v_dot2_f32_bf16 v29, v84, v8, 0
  v_dot2_f32_bf16 v28, v81, v9, v28
  v_dot2_f32_bf16 v29, v85, v9, v29
  v_dot2_f32_bf16 v28, v82, v10, v28
  v_dot2_f32_bf16 v29, v86, v10, v29
  v_dot2_f32_bf16 v28, v83, v11, v28
  v_dot2_f32_bf16 v29, v87, v11, v29
  v_xor_b32 v4, 0x20800, v5
  buffer_load_dwordx4 v[80:83], v4, s[8:11], 0 offen nt
  v_xor_b32 v4, 0x28900, v5
  buffer_load_dwordx4 v[84:87], v4, s[8:11], 0 offen nt
  s_waitcnt vmcnt(30)
  v_dot2_f32_bf16 v30, v88, v8, 0
  v_dot2_f32_bf16 v31, v92, v8, 0
  v_dot2_f32_bf16 v30, v89, v9, v30
  v_dot2_f32_bf16 v31, v93, v9, v31
  v_dot2_f32_bf16 v30, v90, v10, v30
  v_dot2_f32_bf16 v31, v94, v10, v31
  v_dot2_f32_bf16 v30, v91, v11, v30
  v_dot2_f32_bf16 v31, v95, v11, v31
  v_xor_b32 v4, 0xa4400, v5
  buffer_load_dwordx4 v[88:91], v4, s[8:11], 0 offen nt
  v_xor_b32 v4, 0xac500, v5
  buffer_load_dwordx4 v[92:95], v4, s[8:11], 0 offen nt
  s_waitcnt vmcnt(30)
  v_dot2_f32_bf16 v32, v96, v8, 0
  v_dot2_f32_bf16 v33, v100, v8, 0
  v_dot2_f32_bf16 v32, v97, v9, v32
  v_dot2_f32_bf16 v33, v101, v9, v33
  v_dot2_f32_bf16 v32, v98, v10, v32
  v_dot2_f32_bf16 v33, v102, v10, v33
  v_dot2_f32_bf16 v32, v99, v11, v32
  v_dot2_f32_bf16 v33, v103, v11, v33
  s_waitcnt vmcnt(28)
  v_dot2_f32_bf16 v34, v104, v8, 0
  v_dot2_f32_bf16 v35, v108, v8, 0
  v_dot2_f32_bf16 v34, v105, v9, v34
  v_dot2_f32_bf16 v35, v109, v9, v35
  v_dot2_f32_bf16 v34, v106, v10, v34
  v_dot2_f32_bf16 v35, v110, v10, v35
  v_dot2_f32_bf16 v34, v107, v11, v34
  v_dot2_f32_bf16 v35, v111, v11, v35
  s_waitcnt vmcnt(26)
  v_dot2_f32_bf16 v36, v112, v8, 0
  v_dot2_f32_bf16 v37, v116, v8, 0
  v_dot2_f32_bf16 v36, v113, v9, v36
  v_dot2_f32_bf16 v37, v117, v9, v37
  v_dot2_f32_bf16 v36, v114, v10, v36
  v_dot2_f32_bf16 v37, v118, v10, v37
  v_dot2_f32_bf16 v36, v115, v11, v36
  v_dot2_f32_bf16 v37, v119, v11, v37
  s_waitcnt vmcnt(24)
  v_dot2_f32_bf16 v38, v120, v8, 0
  v_dot2_f32_bf16 v39, v124, v8, 0
  v_dot2_f32_bf16 v38, v121, v9, v38
  v_dot2_f32_bf16 v39, v125, v9, v39
  v_dot2_f32_bf16 v38, v122, v10, v38
  v_dot2_f32_bf16 v39, v126, v10, v39
  v_dot2_f32_bf16 v38, v123, v11, v38
  v_dot2_f32_bf16 v39, v127, v11, v39
  s_nop 0
  v_add_f32_dpp v24, v24, v24 row_ror:8 row_mask:0xf bank_mask:0x3
  v_add_f32_dpp v25, v25, v25 row_ror:8 row_mask:0xf bank_mask:0x3
  v_add_f32_dpp v26, v26, v26 row_ror:8 row_mask:0xf bank_mask:0x3
  v_add_f32_dpp v27, v27, v27 row_ror:8 row_mask:0xf bank_mask:0x3
  v_add_f32_dpp v28, v28, v28 row_ror:8 row_mask:0xf bank_mask:0x3
  v_add_f32_dpp v29, v29, v29 row_ror:8 row_mask:0xf bank_mask:0x3
  v_add_f32_dpp v30, v30, v30 row_ror:8 row_mask:0xf bank_mask:0x3
  v_add_f32_dpp v31, v31, v31 row_ror:8 row_mask:0xf bank_mask:0x3
  v_add_f32_dpp v24, v32, v32 row_ror:8 row_mask:0xf bank_mask:0xc
  v_add_f32_dpp v25, v33, v33 row_ror:8 row_mask:0xf bank_mask:0xc
  v_add_f32_dpp v26, v34, v34 row_ror:8 row_mask:0xf bank_mask:0xc
  v_add_f32_dpp v27, v35, v35 row_ror:8 row_mask:0xf bank_mask:0xc
  v_add_f32_dpp v28, v36, v36 row_ror:8 row_mask:0xf bank_mask:0xc
  v_add_f32_dpp v29, v37, v37 row_ror:8 row_mask:0xf bank_mask:0xc
  v_add_f32_dpp v30, v38, v38 row_ror:8 row_mask:0xf bank_mask:0xc
  v_add_f32_dpp v31, v39, v39 row_ror:8 row_mask:0xf bank_mask:0xc
  v_add_f32_dpp v24, v24, v24 row_half_mirror row_mask:0xf bank_mask:0x5
  v_add_f32_dpp v25, v25, v25 row_half_mirror row_mask:0xf bank_mask:0x5
  v_add_f32_dpp v26, v26, v26 row_half_mirror row_mask:0xf bank_mask:0x5
  v_add_f32_dpp v27, v27, v27 row_half_mirror row_mask:0xf bank_mask:0x5
  v_add_f32_dpp v24, v28, v28 row_half_mirror row_mask:0xf bank_mask:0xa
  v_add_f32_dpp v25, v29, v29 row_half_mirror row_mask:0xf bank_mask:0xa
  v_add_f32_dpp v26, v30, v30 row_half_mirror row_mask:0xf bank_mask:0xa
  v_add_f32_dpp v27, v31, v31 row_half_mirror row_mask:0xf bank_mask:0xa
  v_cndmask_b32 v32, v25, v24, s[52:53]
  v_cndmask_b32 v33, v27, v26, s[52:53]
  v_cndmask_b32 v34, v24, v25, s[52:53]
  v_cndmask_b32 v35, v26, v27, s[52:53]
  s_nop 1
  v_add_f32_dpp v34, v32, v34 quad_perm:[1,0,3,2] row_mask:0xf bank_mask:0xf
  v_add_f32_dpp v35, v33, v35 quad_perm:[1,0,3,2] row_mask:0xf bank_mask:0xf
  v_cndmask_b32 v32, v35, v34, s[56:57]
  v_cndmask_b32 v33, v34, v35, s[56:57]
  s_nop 1
  v_add_f32_dpp v46, v32, v33 quad_perm:[2,3,0,1] row_mask:0xf bank_mask:0xf
  s_waitcnt vmcnt(22)
  v_dot2_f32_bf16 v24, v128, v8, 0
  v_dot2_f32_bf16 v25, v132, v8, 0
  v_dot2_f32_bf16 v24, v129, v9, v24
  v_dot2_f32_bf16 v25, v133, v9, v25
  v_dot2_f32_bf16 v24, v130, v10, v24
  v_dot2_f32_bf16 v25, v134, v10, v25
  v_dot2_f32_bf16 v24, v131, v11, v24
  v_dot2_f32_bf16 v25, v135, v11, v25
  v_xor_b32 v4, 0xf4000, v5
  buffer_load_dwordx4 v[96:99], v4, s[8:11], 0 offen nt
  s_waitcnt vmcnt(21)
  v_dot2_f32_bf16 v26, v136, v8, 0
  v_dot2_f32_bf16 v27, v140, v8, 0
  v_dot2_f32_bf16 v26, v137, v9, v26
  v_dot2_f32_bf16 v27, v141, v9, v27
  v_dot2_f32_bf16 v26, v138, v10, v26
  v_dot2_f32_bf16 v27, v142, v10, v27
  v_dot2_f32_bf16 v26, v139, v11, v26
  v_dot2_f32_bf16 v27, v143, v11, v27
  v_xor_b32 v4, 0xfc100, v5
  buffer_load_dwordx4 v[100:103], v4, s[8:11], 0 offen nt
  s_waitcnt vmcnt(20)
  v_dot2_f32_bf16 v28, v144, v8, 0
  v_dot2_f32_bf16 v29, v148, v8, 0
  v_dot2_f32_bf16 v28, v145, v9, v28
  v_dot2_f32_bf16 v29, v149, v9, v29
  v_dot2_f32_bf16 v28, v146, v10, v28
  v_dot2_f32_bf16 v29, v150, v10, v29
  v_dot2_f32_bf16 v28, v147, v11, v28
  v_dot2_f32_bf16 v29, v151, v11, v29
  v_xor_b32 v4, 0x70c00, v5
  buffer_load_dwordx4 v[104:107], v4, s[8:11], 0 offen nt
  s_waitcnt vmcnt(19)
  v_dot2_f32_bf16 v30, v152, v8, 0
  v_dot2_f32_bf16 v31, v156, v8, 0
  v_dot2_f32_bf16 v30, v153, v9, v30
  v_dot2_f32_bf16 v31, v157, v9, v31
  v_dot2_f32_bf16 v30, v154, v10, v30
  v_dot2_f32_bf16 v31, v158, v10, v31
  v_dot2_f32_bf16 v30, v155, v11, v30
  v_dot2_f32_bf16 v31, v159, v11, v31
  v_xor_b32 v4, 0x78d00, v5
  buffer_load_dwordx4 v[108:111], v4, s[8:11], 0 offen nt
  s_waitcnt vmcnt(18)
  v_dot2_f32_bf16 v32, v160, v8, 0
  v_dot2_f32_bf16 v33, v164, v8, 0
  v_dot2_f32_bf16 v32, v161, v9, v32
  v_dot2_f32_bf16 v33, v165, v9, v33
  v_dot2_f32_bf16 v32, v162, v10, v32
  v_dot2_f32_bf16 v33, v166, v10, v33
  v_dot2_f32_bf16 v32, v163, v11, v32
  v_dot2_f32_bf16 v33, v167, v11, v33
  v_xor_b32 v4, 0xf4400, v5
  buffer_load_dwordx4 v[112:115], v4, s[8:11], 0 offen nt
  s_waitcnt vmcnt(17)
  v_dot2_f32_bf16 v34, v168, v8, 0
  v_dot2_f32_bf16 v35, v172, v8, 0
  v_dot2_f32_bf16 v34, v169, v9, v34
  v_dot2_f32_bf16 v35, v173, v9, v35
  v_dot2_f32_bf16 v34, v170, v10, v34
  v_dot2_f32_bf16 v35, v174, v10, v35
  v_dot2_f32_bf16 v34, v171, v11, v34
  v_dot2_f32_bf16 v35, v175, v11, v35
  v_xor_b32 v4, 0xfc500, v5
  buffer_load_dwordx4 v[116:119], v4, s[8:11], 0 offen nt
  s_waitcnt vmcnt(16)
  v_dot2_f32_bf16 v36, v176, v8, 0
  v_dot2_f32_bf16 v37, v180, v8, 0
  v_dot2_f32_bf16 v36, v177, v9, v36
  v_dot2_f32_bf16 v37, v181, v9, v37
  v_dot2_f32_bf16 v36, v178, v10, v36
  v_dot2_f32_bf16 v37, v182, v10, v37
  v_dot2_f32_bf16 v36, v179, v11, v36
  v_dot2_f32_bf16 v37, v183, v11, v37
  v_xor_b32 v4, 0x70800, v5
  buffer_load_dwordx4 v[120:123], v4, s[8:11], 0 offen nt
  s_waitcnt vmcnt(15)
  v_dot2_f32_bf16 v38, v184, v8, 0
  v_dot2_f32_bf16 v39, v188, v8, 0
  v_dot2_f32_bf16 v38, v185, v9, v38
  v_dot2_f32_bf16 v39, v189, v9, v39
  v_dot2_f32_bf16 v38, v186, v10, v38
  v_dot2_f32_bf16 v39, v190, v10, v39
  v_dot2_f32_bf16 v38, v187, v11, v38
  v_dot2_f32_bf16 v39, v191, v11, v39
  v_xor_b32 v4, 0x78900, v5
  buffer_load_dwordx4 v[124:127], v4, s[8:11], 0 offen nt
  s_nop 0
  v_add_f32_dpp v24, v24, v24 row_ror:8 row_mask:0xf bank_mask:0x3
  v_add_f32_dpp v25, v25, v25 row_ror:8 row_mask:0xf bank_mask:0x3
  v_add_f32_dpp v26, v26, v26 row_ror:8 row_mask:0xf bank_mask:0x3
  v_add_f32_dpp v27, v27, v27 row_ror:8 row_mask:0xf bank_mask:0x3
  v_add_f32_dpp v28, v28, v28 row_ror:8 row_mask:0xf bank_mask:0x3
  v_add_f32_dpp v29, v29, v29 row_ror:8 row_mask:0xf bank_mask:0x3
  v_add_f32_dpp v30, v30, v30 row_ror:8 row_mask:0xf bank_mask:0x3
  v_add_f32_dpp v31, v31, v31 row_ror:8 row_mask:0xf bank_mask:0x3
  v_add_f32_dpp v24, v32, v32 row_ror:8 row_mask:0xf bank_mask:0xc
  v_add_f32_dpp v25, v33, v33 row_ror:8 row_mask:0xf bank_mask:0xc
  v_add_f32_dpp v26, v34, v34 row_ror:8 row_mask:0xf bank_mask:0xc
  v_add_f32_dpp v27, v35, v35 row_ror:8 row_mask:0xf bank_mask:0xc
  v_add_f32_dpp v28, v36, v36 row_ror:8 row_mask:0xf bank_mask:0xc
  v_add_f32_dpp v29, v37, v37 row_ror:8 row_mask:0xf bank_mask:0xc
  v_add_f32_dpp v30, v38, v38 row_ror:8 row_mask:0xf bank_mask:0xc
  v_add_f32_dpp v31, v39, v39 row_ror:8 row_mask:0xf bank_mask:0xc
  v_add_f32_dpp v24, v24, v24 row_half_mirror row_mask:0xf bank_mask:0x5
  v_add_f32_dpp v25, v25, v25 row_half_mirror row_mask:0xf bank_mask:0x5
  v_add_f32_dpp v26, v26, v26 row_half_mirror row_mask:0xf bank_mask:0x5
  v_add_f32_dpp v27, v27, v27 row_half_mirror row_mask:0xf bank_mask:0x5
  v_add_f32_dpp v24, v28, v28 row_half_mirror row_mask:0xf bank_mask:0xa
  v_add_f32_dpp v25, v29, v29 row_half_mirror row_mask:0xf bank_mask:0xa
  v_add_f32_dpp v26, v30, v30 row_half_mirror row_mask:0xf bank_mask:0xa
  v_add_f32_dpp v27, v31, v31 row_half_mirror row_mask:0xf bank_mask:0xa
  v_cndmask_b32 v32, v25, v24, s[52:53]
  v_cndmask_b32 v33, v27, v26, s[52:53]
  v_cndmask_b32 v34, v24, v25, s[52:53]
  v_cndmask_b32 v35, v26, v27, s[52:53]
  s_nop 1
  v_add_f32_dpp v34, v32, v34 quad_perm:[1,0,3,2] row_mask:0xf bank_mask:0xf
  v_add_f32_dpp v35, v33, v35 quad_perm:[1,0,3,2] row_mask:0xf bank_mask:0xf
  v_cndmask_b32 v32, v35, v34, s[56:57]
  v_cndmask_b32 v33, v34, v35, s[56:57]
  s_nop 1
  v_add_f32_dpp v47, v32, v33 quad_perm:[2,3,0,1] row_mask:0xf bank_mask:0xf
  s_waitcnt vmcnt(15)
  v_dot2_f32_bf16 v24, v64, v8, 0
  v_dot2_f32_bf16 v24, v65, v9, v24
  v_dot2_f32_bf16 v24, v66, v10, v24
  v_dot2_f32_bf16 v24, v67, v11, v24
  s_waitcnt vmcnt(14)
  v_dot2_f32_bf16 v25, v68, v8, 0
  v_dot2_f32_bf16 v25, v69, v9, v25
  v_dot2_f32_bf16 v25, v70, v10, v25
  v_dot2_f32_bf16 v25, v71, v11, v25
  s_waitcnt vmcnt(13)
  v_dot2_f32_bf16 v26, v72, v8, 0
  v_dot2_f32_bf16 v26, v73, v9, v26
  v_dot2_f32_bf16 v26, v74, v10, v26
  v_dot2_f32_bf16 v26, v75, v11, v26
  s_waitcnt vmcnt(12)
  v_dot2_f32_bf16 v27, v76, v8, 0
  v_dot2_f32_bf16 v27, v77, v9, v27
  v_dot2_f32_bf16 v27, v78, v10, v27
  v_dot2_f32_bf16 v27, v79, v11, v27
  s_waitcnt vmcnt(11)
  v_dot2_f32_bf16 v28, v80, v8, 0
  v_dot2_f32_bf16 v28, v81, v9, v28
  v_dot2_f32_bf16 v28, v82, v10, v28
  v_dot2_f32_bf16 v28, v83, v11, v28
  s_waitcnt vmcnt(10)
  v_dot2_f32_bf16 v29, v84, v8, 0
  v_dot2_f32_bf16 v29, v85, v9, v29
  v_dot2_f32_bf16 v29, v86, v10, v29
  v_dot2_f32_bf16 v29, v87, v11, v29
  s_waitcnt vmcnt(9)
  v_dot2_f32_bf16 v30, v88, v8, 0
  v_dot2_f32_bf16 v30, v89, v9, v30
  v_dot2_f32_bf16 v30, v90, v10, v30
  v_dot2_f32_bf16 v30, v91, v11, v30
  s_waitcnt vmcnt(8)
  v_dot2_f32_bf16 v31, v92, v8, 0
  v_dot2_f32_bf16 v31, v93, v9, v31
  v_dot2_f32_bf16 v31, v94, v10, v31
  v_dot2_f32_bf16 v31, v95, v11, v31
  s_mov_b32 s54, 2
  v_and_b32 v12, 63, v0
  v_lshlrev_b32 v12, 2, v12
  v_mov_b32 v56, 1
  v_mov_b32 v59, 0
  s_mov_b32 s62, 23
  ds_read_b32 v61, v59 offset:8720
  s_branch L_kmid
L_kloop:
  s_cmp_eq_u32 s54, s60
  s_cbranch_scc1 L_burst
L_nobu:
  v_xor_b32 v4, 0xd4c00, v58
  s_waitcnt vmcnt(7)
  s_cmp_ge_u32 s62, 32
  s_cbranch_scc1 L_cw1
  s_waitcnt vmcnt(6)
  s_cmp_ge_u32 s62, 28
  s_cbranch_scc1 L_cw1
  s_waitcnt vmcnt(5)
  s_cmp_ge_u32 s62, 24
  s_cbranch_scc1 L_cw1
  s_waitcnt vmcnt(4)
  s_cmp_ge_u32 s62, 20
  s_cbranch_scc1 L_cw1
  s_waitcnt vmcnt(3)
L_cw1:
  buffer_load_dwordx4 v[96:99], v4, s[8:11], 0 offen nt
  v_dot2_f32_bf16 v24, v64, v8, 0
  v_dot2_f32_bf16 v24, v65, v9, v24
  v_dot2_f32_bf16 v24, v66, v10, v24
  v_dot2_f32_bf16 v24, v67, v11, v24
  ds_add_u32 v12, v56 offset:11776
  s_waitcnt lgkmcnt(1)
  v_readfirstlane_b32 s62, v61
  v_xor_b32 v4, 0xdcd00, v58
  s_waitcnt vmcnt(7)
  s_cmp_ge_u32 s62, 31
  s_cbranch_scc1 L_cw2
  s_waitcnt vmcnt(6)
  s_cmp_ge_u32 s62, 27
  s_cbranch_scc1 L_cw2
  s_waitcnt vmcnt(5)
  s_cmp_ge_u32 s62, 23
  s_cbranch_scc1 L_cw2
  s_waitcnt vmcnt(4)
  s_cmp_ge_u32 s62, 19
  s_cbranch_scc1 L_cw2
  s_waitcnt vmcnt(3)
L_cw2:
  buffer_load_dwordx4 v[100:103], v4, s[8:11], 0 offen nt
  v_dot2_f32_bf16 v25, v68, v8, 0
  v_dot2_f32_bf16 v25, v69, v9, v25
  v_dot2_f32_bf16 v25, v70, v10, v25
  v_dot2_f32_bf16 v25, v71, v11, v25
  ds_read_b32 v61, v59 offset:8720
  v_xor_b32 v4, 0x50000, v58
  s_waitcnt vmcnt(7)
  s_cmp_ge_u32 s62, 30
  s_cbranch_scc1 L_cw3
  s_waitcnt vmcnt(6)
  s_cmp_ge_u32 s62, 26
  s_cbranch_scc1 L_cw3
  s_waitcnt vmcnt(5)
  s_cmp_ge_u32 s62, 22
  s_cbranch_scc1 L_cw3
  s_waitcnt vmcnt(4)
  s_cmp_ge_u32 s62, 18
  s_cbranch_scc1 L_cw3
  s_waitcnt vmcnt(3)
L_cw3:
  buffer_load_dwordx4 v[104:107], v4, s[8:11], 0 offen nt
  v_dot2_f32_bf16 v26, v72, v8, 0
  v_dot2_f32_bf16 v26, v73, v9, v26
  v_dot2_f32_bf16 v26, v74, v10, v26
  v_dot2_f32_bf16 v26, v75, v11, v26
  ds_add_u32 v12, v56 offset:11776
  s_waitcnt lgkmcnt(1)
  v_readfirstlane_b32 s62, v61
  v_xor_b32 v4, 0x58100, v58
  s_waitcnt vmcnt(7)
  s_cmp_ge_u32 s62, 29
  s_cbranch_scc1 L_cw4
  s_waitcnt vmcnt(6)
  s_cmp_ge_u32 s62, 25
  s_cbranch_scc1 L_cw4
  s_waitcnt vmcnt(5)
  s_cmp_ge_u32 s62, 21
  s_cbranch_scc1 L_cw4
  s_waitcnt vmcnt(4)
  s_cmp_ge_u32 s62, 17
  s_cbranch_scc1 L_cw4
  s_waitcnt vmcnt(3)
L_cw4:
  buffer_load_dwordx4 v[108:111], v4, s[8:11], 0 offen nt
  v_dot2_f32_bf16 v27, v76, v8, 0
  v_dot2_f32_bf16 v27, v77, v9, v27
  v_dot2_f32_bf16 v27, v78, v10, v27
  v_dot2_f32_bf16 v27, v79, v11, v27
  ds_read_b32 v61, v59 offset:8720
  v_xor_b32 v4, 0xd4800, v58
  s_waitcnt vmcnt(7)
  s_cmp_ge_u32 s62, 32
  s_cbranch_scc1 L_cw5
  s_waitcnt vmcnt(6)
  s_cmp_ge_u32 s62, 28
  s_cbranch_scc1 L_cw5
  s_waitcnt vmcnt(5)
  s_cmp_ge_u32 s62, 24
  s_cbranch_scc1 L_cw5
  s_waitcnt vmcnt(4)
  s_cmp_ge_u32 s62, 20
  s_cbranch_scc1 L_cw5
  s_waitcnt vmcnt(3)
L_cw5:
  buffer_load_dwordx4 v[112:115], v4, s[8:11], 0 offen nt
  v_dot2_f32_bf16 v28, v80, v8, 0
  v_dot2_f32_bf16 v28, v81, v9, v28
  v_dot2_f32_bf16 v28, v82, v10, v28
  v_dot2_f32_bf16 v28, v83, v11, v28
  ds_add_u32 v12, v56 offset:11776
  s_waitcnt lgkmcnt(1)
  v_readfirstlane_b32 s62, v61
  v_xor_b32 v4, 0xdc900, v58
  s_waitcnt vmcnt(7)
  s_cmp_ge_u32 s62, 31
  s_cbranch_scc1 L_cw6
  s_waitcnt vmcnt(6)
  s_cmp_ge_u32 s62, 27
  s_cbranch_scc1 L_cw6
  s_waitcnt vmcnt(5)
  s_cmp_ge_u32 s62, 23
  s_cbranch_scc1 L_cw6
  s_waitcnt vmcnt(4)
  s_cmp_ge_u32 s62, 19
  s_cbranch_scc1 L_cw6
  s_waitcnt vmcnt(3)
L_cw6:
  buffer_load_dwordx4 v[116:119], v4, s[8:11], 0 offen nt
  v_dot2_f32_bf16 v29, v84, v8, 0
  v_dot2_f32_bf16 v29, v85, v9, v29
  v_dot2_f32_bf16 v29, v86, v10, v29
  v_dot2_f32_bf16 v29, v87, v11, v29
  ds_read_b32 v61, v59 offset:8720
  v_xor_b32 v4, 0x50400, v58
  s_waitcnt vmcnt(7)
  s_cmp_ge_u32 s62, 30
  s_cbranch_scc1 L_cw7
  s_waitcnt vmcnt(6)
  s_cmp_ge_u32 s62, 26
  s_cbranch_scc1 L_cw7
  s_waitcnt vmcnt(5)
  s_cmp_ge_u32 s62, 22
  s_cbranch_scc1 L_cw7
  s_waitcnt vmcnt(4)
  s_cmp_ge_u32 s62, 18
  s_cbranch_scc1 L_cw7
  s_waitcnt vmcnt(3)
L_cw7:
  buffer_load_dwordx4 v[120:123], v4, s[8:11], 0 offen nt
  v_dot2_f32_bf16 v30, v88, v8, 0
  v_dot2_f32_bf16 v30, v89, v9, v30
  v_dot2_f32_bf16 v30, v90, v10, v30
  v_dot2_f32_bf16 v30, v91, v11, v30
  ds_add_u32 v12, v56 offset:11776
  s_waitcnt lgkmcnt(1)
  v_readfirstlane_b32 s62, v61
  v_xor_b32 v4, 0x58500, v58
  s_waitcnt vmcnt(7)
  s_cmp_ge_u32 s62, 29
  s_cbranch_scc1 L_cw8
  s_waitcnt vmcnt(6)
  s_cmp_ge_u32 s62, 25
  s_cbranch_scc1 L_cw8
  s_waitcnt vmcnt(5)
  s_cmp_ge_u32 s62, 21
  s_cbranch_scc1 L_cw8
  s_waitcnt vmcnt(4)
  s_cmp_ge_u32 s62, 17
  s_cbranch_scc1 L_cw8
  s_waitcnt vmcnt(3)
L_cw8:
  buffer_load_dwordx4 v[124:127], v4, s[8:11], 0 offen nt
  v_dot2_f32_bf16 v31, v92, v8, 0
  v_dot2_f32_bf16 v31, v93, v9, v31
  v_dot2_f32_bf16 v31, v94, v10, v31
  v_dot2_f32_bf16 v31, v95, v11, v31
  ds_read_b32 v61, v59 offset:8720
L_kmid:
  s_add_u32 s42, s54, 1
  s_bitcmp1_b32 s42, 0
  s_cselect_b32 s50, 0x40000, 0
  s_bitcmp1_b32 s42, 1
  s_cselect_b32 s6, 0x20c00, 0
  s_xor_b32 s50, s50, s6
  s_bitcmp1_b32 s42, 2
  s_cselect_b32 s6, 0x20400, 0
  s_xor_b32 s50, s50, s6
  v_xor_b32 v58, s50, v5
  s_cmp_eq_u32 s54, 7
  s_cselect_b32 s44, s12, s8
  s_cselect_b32 s45, s13, s9
  s_waitcnt vmcnt(7)
  s_cmp_ge_u32 s62, 32
  s_cbranch_scc1 L_cw9
  s_waitcnt vmcnt(6)
  s_cmp_ge_u32 s62, 28
  s_cbranch_scc1 L_cw9
  s_waitcnt vmcnt(5)
  s_cmp_ge_u32 s62, 24
  s_cbranch_scc1 L_cw9
  s_waitcnt vmcnt(4)
  s_cmp_ge_u32 s62, 20
  s_cbranch_scc1 L_cw9
  s_waitcnt vmcnt(3)
L_cw9:
  buffer_load_dwordx4 v[64:67], v58, s[44:47], 0 offen nt
  v_dot2_f32_bf16 v32, v96, v8, 0
  v_dot2_f32_bf16 v32, v97, v9, v32
  v_dot2_f32_bf16 v32, v98, v10, v32
  v_dot2_f32_bf16 v32, v99, v11, v32
  ds_add_u32 v12, v56 offset:11776
  s_waitcnt lgkmcnt(1)
  v_readfirstlane_b32 s62, v61
  v_xor_b32 v4, 0x8100, v58
  s_waitcnt vmcnt(7)
  s_cmp_ge_u32 s62, 31
  s_cbranch_scc1 L_cw10
  s_waitcnt vmcnt(6)
  s_cmp_ge_u32 s62, 27
  s_cbranch_scc1 L_cw10
  s_waitcnt vmcnt(5)
  s_cmp_ge_u32 s62, 23
  s_cbranch_scc1 L_cw10
  s_waitcnt vmcnt(4)
  s_cmp_ge_u32 s62, 19
  s_cbranch_scc1 L_cw10
  s_waitcnt vmcnt(3)
L_cw10:
  buffer_load_dwordx4 v[68:71], v4, s[44:47], 0 offen nt
  v_dot2_f32_bf16 v33, v100, v8, 0
  v_dot2_f32_bf16 v33, v101, v9, v33
  v_dot2_f32_bf16 v33, v102, v10, v33
  v_dot2_f32_bf16 v33, v103, v11, v33
  ds_read_b32 v61, v59 offset:8720
  v_xor_b32 v4, 0x84c00, v58
  s_waitcnt vmcnt(7)
  s_cmp_ge_u32 s62, 30
  s_cbranch_scc1 L_cw11
  s_waitcnt vmcnt(6)
  s_cmp_ge_u32 s62, 26
  s_cbranch_scc1 L_cw11
  s_waitcnt vmcnt(5)
  s_cmp_ge_u32 s62, 22
  s_cbranch_scc1 L_cw11
  s_waitcnt vmcnt(4)
  s_cmp_ge_u32 s62, 18
  s_cbranch_scc1 L_cw11
  s_waitcnt vmcnt(3)
L_cw11:
  buffer_load_dwordx4 v[72:75], v4, s[44:47], 0 offen nt
  v_dot2_f32_bf16 v34, v104, v8, 0
  v_dot2_f32_bf16 v34, v105, v9, v34
  v_dot2_f32_bf16 v34, v106, v10, v34
  v_dot2_f32_bf16 v34, v107, v11, v34
  ds_add_u32 v12, v56 offset:11776
  s_waitcnt lgkmcnt(1)
  v_readfirstlane_b32 s62, v61
  v_xor_b32 v4, 0x8cd00, v58
  s_waitcnt vmcnt(7)
  s_cmp_ge_u32 s62, 29
  s_cbranch_scc1 L_cw12
  s_waitcnt vmcnt(6)
  s_cmp_ge_u32 s62, 25
  s_cbranch_scc1 L_cw12
  s_waitcnt vmcnt(5)
  s_cmp_ge_u32 s62, 21
  s_cbranch_scc1 L_cw12
  s_waitcnt vmcnt(4)
  s_cmp_ge_u32 s62, 17
  s_cbranch_scc1 L_cw12
  s_waitcnt vmcnt(3)
L_cw12:
  buffer_load_dwordx4 v[76:79], v4, s[44:47], 0 offen nt
  v_dot2_f32_bf16 v35, v108, v8, 0
  v_dot2_f32_bf16 v35, v109, v9, v35
  v_dot2_f32_bf16 v35, v110, v10, v35
  v_dot2_f32_bf16 v35, v111, v11, v35
  ds_read_b32 v61, v59 offset:8720
  v_xor_b32 v4, 0x400, v58
  s_waitcnt vmcnt(7)
  s_cmp_ge_u32 s62, 32
  s_cbranch_scc1 L_cw13
  s_waitcnt vmcnt(6)
  s_cmp_ge_u32 s62, 28
  s_cbranch_scc1 L_cw13
  s_waitcnt vmcnt(5)
  s_cmp_ge_u32 s62, 24
  s_cbranch_scc1 L_cw13
  s_waitcnt vmcnt(4)
  s_cmp_ge_u32 s62, 20
  s_cbranch_scc1 L_cw13
  s_waitcnt vmcnt(3)
L_cw13:
  buffer_load_dwordx4 v[80:83], v4, s[44:47], 0 offen nt
  v_dot2_f32_bf16 v36, v112, v8, 0
  v_dot2_f32_bf16 v36, v113, v9, v36
  v_dot2_f32_bf16 v36, v114, v10, v36
  v_dot2_f32_bf16 v36, v115, v11, v36
  ds_add_u32 v12, v56 offset:11776
  s_waitcnt lgkmcnt(1)
  v_readfirstlane_b32 s62, v61
  v_xor_b32 v4, 0x8500, v58
  s_waitcnt vmcnt(7)
  s_cmp_ge_u32 s62, 31
  s_cbranch_scc1 L_cw14
  s_waitcnt vmcnt(6)
  s_cmp_ge_u32 s62, 27
  s_cbranch_scc1 L_cw14
  s_waitcnt vmcnt(5)
  s_cmp_ge_u32 s62, 23
  s_cbranch_scc1 L_cw14
  s_waitcnt vmcnt(4)
  s_cmp_ge_u32 s62, 19
  s_cbranch_scc1 L_cw14
  s_waitcnt vmcnt(3)
L_cw14:
  buffer_load_dwordx4 v[84:87], v4, s[44:47], 0 offen nt
  v_dot2_f32_bf16 v37, v116, v8, 0
  v_dot2_f32_bf16 v37, v117, v9, v37
  v_dot2_f32_bf16 v37, v118, v10, v37
  v_dot2_f32_bf16 v37, v119, v11, v37
  ds_read_b32 v61, v59 offset:8720
  v_xor_b32 v4, 0x84800, v58
  s_waitcnt vmcnt(7)
  s_cmp_ge_u32 s62, 30
  s_cbranch_scc1 L_cw15
  s_waitcnt vmcnt(6)
  s_cmp_ge_u32 s62, 26
  s_cbranch_scc1 L_cw15
  s_waitcnt vmcnt(5)
  s_cmp_ge_u32 s62, 22
  s_cbranch_scc1 L_cw15
  s_waitcnt vmcnt(4)
  s_cmp_ge_u32 s62, 18
  s_cbranch_scc1 L_cw15
  s_waitcnt vmcnt(3)
L_cw15:
  buffer_load_dwordx4 v[88:91], v4, s[44:47], 0 offen nt
  v_dot2_f32_bf16 v38, v120, v8, 0
  v_dot2_f32_bf16 v38, v121, v9, v38
  v_dot2_f32_bf16 v38, v122, v10, v38
  v_dot2_f32_bf16 v38, v123, v11, v38
  ds_add_u32 v12, v56 offset:11776
  s_waitcnt lgkmcnt(1)
  v_readfirstlane_b32 s62, v61
  v_xor_b32 v4, 0x8c900, v58
  s_waitcnt vmcnt(7)
  s_cmp_ge_u32 s62, 29
  s_cbranch_scc1 L_cw16
  s_waitcnt vmcnt(6)
  s_cmp_ge_u32 s62, 25
  s_cbranch_scc1 L_cw16
  s_waitcnt vmcnt(5)
  s_cmp_ge_u32 s62, 21
  s_cbranch_scc1 L_cw16
  s_waitcnt vmcnt(4)
  s_cmp_ge_u32 s62, 17
  s_cbranch_scc1 L_cw16
  s_waitcnt vmcnt(3)
L_cw16:
  buffer_load_dwordx4 v[92:95], v4, s[44:47], 0 offen nt
  v_dot2_f32_bf16 v39, v124, v8, 0
  v_dot2_f32_bf16 v39, v125, v9, v39
  v_dot2_f32_bf16 v39, v126, v10, v39
  v_dot2_f32_bf16 v39, v127, v11, v39
  ds_read_b32 v61, v59 offset:8720
  v_mov_b32 v40, v41
  v_mov_b32 v41, v42
  v_mov_b32 v42, v43
  v_mov_b32 v43, v44
  v_mov_b32 v44, v45
  v_mov_b32 v45, v46
  v_mov_b32 v46, v47
  v_add_f32_dpp v24, v24, v24 row_ror:8 row_mask:0xf bank_mask:0x3
  v_add_f32_dpp v25, v25, v25 row_ror:8 row_mask:0xf bank_mask:0x3
  v_add_f32_dpp v26, v26, v26 row_ror:8 row_mask:0xf bank_mask:0x3
  v_add_f32_dpp v27, v27, v27 row_ror:8 row_mask:0xf bank_mask:0x3
  v_add_f32_dpp v28, v28, v28 row_ror:8 row_mask:0xf bank_mask:0x3
  v_add_f32_dpp v29, v29, v29 row_ror:8 row_mask:0xf bank_mask:0x3
  v_add_f32_dpp v30, v30, v30 row_ror:8 row_mask:0xf bank_mask:0x3
  v_add_f32_dpp v31, v31, v31 row_ror:8 row_mask:0xf bank_mask:0x3
  v_add_f32_dpp v24, v32, v32 row_ror:8 row_mask:0xf bank_mask:0xc
  v_add_f32_dpp v25, v33, v33 row_ror:8 row_mask:0xf bank_mask:0xc
  v_add_f32_dpp v26, v34, v34 row_ror:8 row_mask:0xf bank_mask:0xc
  v_add_f32_dpp v27, v35, v35 row_ror:8 row_mask:0xf bank_mask:0xc
  v_add_f32_dpp v28, v36, v36 row_ror:8 row_mask:0xf bank_mask:0xc
  v_add_f32_dpp v29, v37, v37 row_ror:8 row_mask:0xf bank_mask:0xc
  v_add_f32_dpp v30, v38, v38 row_ror:8 row_mask:0xf bank_mask:0xc
  v_add_f32_dpp v31, v39, v39 row_ror:8 row_mask:0xf bank_mask:0xc
  v_add_f32_dpp v24, v24, v24 row_half_mirror row_mask:0xf bank_mask:0x5
  v_add_f32_dpp v25, v25, v25 row_half_mirror row_mask:0xf bank_mask:0x5
  v_add_f32_dpp v26, v26, v26 row_half_mirror row_mask:0xf bank_mask:0x5
  v_add_f32_dpp v27, v27, v27 row_half_mirror row_mask:0xf bank_mask:0x5
  v_add_f32_dpp v24, v28, v28 row_half_mirror row_mask:0xf bank_mask:0xa
  v_add_f32_dpp v25, v29, v29 row_half_mirror row_mask:0xf bank_mask:0xa
  v_add_f32_dpp v26, v30, v30 row_half_mirror row_mask:0xf bank_mask:0xa
  v_add_f32_dpp v27, v31, v31 row_half_mirror row_mask:0xf bank_mask:0xa
  v_cndmask_b32 v32, v25, v24, s[52:53]
  v_cndmask_b32 v33, v27, v26, s[52:53]
  v_cndmask_b32 v34, v24, v25, s[52:53]
  v_cndmask_b32 v35, v26, v27, s[52:53]
  s_nop 1
  v_add_f32_dpp v34, v32, v34 quad_perm:[1,0,3,2] row_mask:0xf bank_mask:0xf
  v_add_f32_dpp v35, v33, v35 quad_perm:[1,0,3,2] row_mask:0xf bank_mask:0xf
  v_cndmask_b32 v32, v35, v34, s[56:57]
  v_cndmask_b32 v33, v34, v35, s[56:57]
  s_add_u32 s54, s54, 1
  s_cmp_lt_u32 s54, 8
  v_add_f32_dpp v47, v32, v33 quad_perm:[2,3,0,1] row_mask:0xf bank_mask:0xf
  s_cbranch_scc1 L_kloop
L_soft:
  v_xor_b32 v4, 0xd4c00, v58
  s_waitcnt vmcnt(5)
  buffer_load_dwordx4 v[96:99], v4, s[12:15], 0 offen nt
  s_mov_b32 s58, 0x3e0293ee
  v_max3_f32 v14, v40, v41, v42
  v_max3_f32 v14, v14, v43, v44
  v_max3_f32 v14, v14, v45, v46
  v_max_f32 v14, v14, v47
  v_xor_b32 v4, 0xdcd00, v58
  s_waitcnt vmcnt(5)
  buffer_load_dwordx4 v[100:103], v4, s[12:15], 0 offen nt
  s_nop 1
  v_max_f32_dpp v14, v14, v14 quad_perm:[1,0,3,2] row_mask:0xf bank_mask:0xf
  s_nop 1
  v_max_f32_dpp v14, v14, v14 quad_perm:[2,3,0,1] row_mask:0xf bank_mask:0xf
  s_nop 1
  v_max_f32_dpp v14, v14, v14 row_half_mirror row_mask:0xf bank_mask:0xf
  s_nop 1
  v_max_f32_dpp v14, v14, v14 row_mirror row_mask:0xf bank_mask:0xf
  v_mul_f32 v14, s58, v14
  v_fma_f32 v40, v40, s58, -v14
  v_fma_f32 v41, v41, s58, -v14
  v_fma_f32 v42, v42, s58, -v14
  v_fma_f32 v43, v43, s58, -v14
  v_fma_f32 v44, v44, s58, -v14
  v_fma_f32 v45, v45, s58, -v14
  v_fma_f32 v46, v46, s58, -v14
  v_fma_f32 v47, v47, s58, -v14
  v_exp_f32 v40, v40
  v_exp_f32 v41, v41
  v_exp_f32 v42, v42
  v_exp_f32 v43, v43
  v_exp_f32 v44, v44
  v_exp_f32 v45, v45
  v_exp_f32 v46, v46
  v_exp_f32 v47, v47
  v_mov_b32 v48, 0
  v_mov_b32 v49, 0
  v_mov_b32 v50, 0
  v_mov_b32 v51, 0
  v_mov_b32 v52, 0
  v_mov_b32 v53, 0
  v_mov_b32 v54, 0
  v_mov_b32 v55, 0
  v_add_f32 v15, v40, v41
  v_add_f32 v15, v15, v42
  v_add_f32 v15, v15, v43
  v_add_f32 v15, v15, v44
  v_add_f32 v15, v15, v45
  v_add_f32 v15, v15, v46
  v_add_f32 v15, v15, v47
  v_xor_b32 v4, 0x50000, v58
  s_waitcnt vmcnt(5)
  buffer_load_dwordx4 v[104:107], v4, s[12:15], 0 offen nt
  s_nop 1
  v_add_f32_dpp v15, v15, v15 quad_perm:[1,0,3,2] row_mask:0xf bank_mask:0xf
  s_nop 1
  v_add_f32_dpp v15, v15, v15 quad_perm:[2,3,0,1] row_mask:0xf bank_mask:0xf
  s_nop 1
  v_add_f32_dpp v15, v15, v15 row_half_mirror row_mask:0xf bank_mask:0xf
  s_nop 1
  v_add_f32_dpp v15, v15, v15 row_mirror row_mask:0xf bank_mask:0xf
  v_lshlrev_b32 v16, 2, v6
  v_lshlrev_b32 v18, 2, v0
  ds_write_b32 v18, v47 offset:12032
  v_min_u32 v14, -2, v14
  v_min_u32 v15, -2, v15
  ds_write_b32 v16, v14 offset:8448
  ds_write_b32 v16, v15 offset:8512
  s_mov_b32 s54, 0
  v_and_b32 v19, 0xfc, v18
  v_mov_b32 v56, 1
  v_xor_b32 v4, 0x58100, v58
  s_waitcnt vmcnt(5)
  buffer_load_dwordx4 v[108:111], v4, s[12:15], 0 offen nt
  v_mov_b32 v57, 2
  ds_add_u32 v19, v57 offset:11776
  s_mov_b32 s61, 132
L_vloop:
  s_cmp_lg_u32 s54, 6
  s_cbranch_scc1 L_nocf
  v_and_b32 v17, 1, v6
  v_lshl_add_u32 v17, v17, 3, v7
  v_bfe_u32 v21, v6, 1, 1
  v_lshl_add_u32 v17, v21, 2, v17
  s_lshl_b32 s42, s3, 9
  v_lshl_add_u32 v17, v17, 1, s42
  s_lshl_b32 s42, s59, 8
  s_add_u32 s42, s42, 0x40000
  v_lshlrev_b32 v22, 1, v19
  v_add_u32 v21, s42, v19
  s_mov_b32 s55, 262144
L_sp_cf:
  ds_read_b32 v57, v16 offset:8576
  s_waitcnt lgkmcnt(0)
  v_cmp_eq_u32 vcc, -1, v57
  s_cbranch_vccz L_sp_cf_done
  s_sleep 1
  s_sub_u32 s55, s55, 1
  s_cmp_lg_u32 s55, 0
  s_cbranch_scc1 L_sp_cf
L_sp_cf_done:
  v_mul_f32 v48, v57, v48
  v_mul_f32 v49, v57, v49
  v_mul_f32 v50, v57, v50
  v_mul_f32 v51, v57, v51
  v_mul_f32 v52, v57, v52
  v_mul_f32 v53, v57, v53
  v_mul_f32 v54, v57, v54
  v_mul_f32 v55, v57, v55
  v_mul_f32 v40, v57, v40
  v_mul_f32 v41, v57, v41
L_nocf:
  s_waitcnt lgkmcnt(0)
  v_cvt_pk_bf16_f32 v12, v40, 0
  v_cvt_pk_bf16_f32 v13, 0, v40
  v_mov_b32 v40, v41
  v_mov_b32 v41, v42
  v_mov_b32 v42, v43
  v_mov_b32 v43, v44
  v_mov_b32 v44, v45
  v_mov_b32 v45, v46
  v_mov_b32 v46, v47
  v_xor_b32 v4, 0xd4800, v58
  s_cmp_gt_i32 s61, 0
  s_cbranch_scc0 L_dr0
  s_waitcnt vmcnt(11)
  s_cmp_ge_u32 s62, 48
  s_cbranch_scc1 L_cw17
  s_waitcnt vmcnt(9)
  s_cmp_ge_u32 s62, 40
  s_cbranch_scc1 L_cw17
  s_waitcnt vmcnt(7)
  s_cmp_ge_u32 s62, 32
  s_cbranch_scc1 L_cw17
  s_waitcnt vmcnt(6)
  s_cmp_ge_u32 s62, 28
  s_cbranch_scc1 L_cw17
  s_waitcnt vmcnt(5)
  s_cmp_ge_u32 s62, 24
  s_cbranch_scc1 L_cw17
  s_waitcnt vmcnt(4)
  s_cmp_ge_u32 s62, 20
  s_cbranch_scc1 L_cw17
  s_waitcnt vmcnt(3)
L_cw17:
  buffer_load_dwordx4 v[112:115], v4, s[12:15], 0 offen nt
  v_dot2c_f32_bf16_dpp v48, v12, v64 row_newbcast:0 row_mask:0xf bank_mask:0xf
  v_dot2c_f32_bf16_dpp v49, v13, v64 row_newbcast:0 row_mask:0xf bank_mask:0xf
  v_dot2c_f32_bf16_dpp v50, v12, v65 row_newbcast:0 row_mask:0xf bank_mask:0xf
  v_dot2c_f32_bf16_dpp v51, v13, v65 row_newbcast:0 row_mask:0xf bank_mask:0xf
  v_dot2c_f32_bf16_dpp v52, v12, v66 row_newbcast:0 row_mask:0xf bank_mask:0xf
  v_dot2c_f32_bf16_dpp v53, v13, v66 row_newbcast:0 row_mask:0xf bank_mask:0xf
  v_dot2c_f32_bf16_dpp v54, v12, v67 row_newbcast:0 row_mask:0xf bank_mask:0xf
  v_dot2c_f32_bf16_dpp v55, v13, v67 row_newbcast:0 row_mask:0xf bank_mask:0xf
  ds_add_u32 v19, v56 offset:11776
  s_waitcnt lgkmcnt(1)
  v_readfirstlane_b32 s62, v61
  v_xor_b32 v4, 0xdc900, v58
  s_cmp_gt_i32 s61, 1
  s_cbranch_scc0 L_dr1
  s_waitcnt vmcnt(11)
  s_cmp_ge_u32 s62, 47
  s_cbranch_scc1 L_cw18
  s_waitcnt vmcnt(9)
  s_cmp_ge_u32 s62, 39
  s_cbranch_scc1 L_cw18
  s_waitcnt vmcnt(7)
  s_cmp_ge_u32 s62, 31
  s_cbranch_scc1 L_cw18
  s_waitcnt vmcnt(6)
  s_cmp_ge_u32 s62, 27
  s_cbranch_scc1 L_cw18
  s_waitcnt vmcnt(5)
  s_cmp_ge_u32 s62, 23
  s_cbranch_scc1 L_cw18
  s_waitcnt vmcnt(4)
  s_cmp_ge_u32 s62, 19
  s_cbranch_scc1 L_cw18
  s_waitcnt vmcnt(3)
L_cw18:
  buffer_load_dwordx4 v[116:119], v4, s[12:15], 0 offen nt
  v_dot2c_f32_bf16_dpp v48, v12, v68 row_newbcast:1 row_mask:0xf bank_mask:0xf
  v_dot2c_f32_bf16_dpp v49, v13, v68 row_newbcast:1 row_mask:0xf bank_mask:0xf
  v_dot2c_f32_bf16_dpp v50, v12, v69 row_newbcast:1 row_mask:0xf bank_mask:0xf
  v_dot2c_f32_bf16_dpp v51, v13, v69 row_newbcast:1 row_mask:0xf bank_mask:0xf
  v_dot2c_f32_bf16_dpp v52, v12, v70 row_newbcast:1 row_mask:0xf bank_mask:0xf
  v_dot2c_f32_bf16_dpp v53, v13, v70 row_newbcast:1 row_mask:0xf bank_mask:0xf
  v_dot2c_f32_bf16_dpp v54, v12, v71 row_newbcast:1 row_mask:0xf bank_mask:0xf
  v_dot2c_f32_bf16_dpp v55, v13, v71 row_newbcast:1 row_mask:0xf bank_mask:0xf
  ds_read_b32 v61, v59 offset:8720
  v_xor_b32 v4, 0x50400, v58
  s_cmp_gt_i32 s61, 2
  s_cbranch_scc0 L_dr2
  s_waitcnt vmcnt(11)
  s_cmp_ge_u32 s62, 46
  s_cbranch_scc1 L_cw19
  s_waitcnt vmcnt(9)
  s_cmp_ge_u32 s62, 38
  s_cbranch_scc1 L_cw19
  s_waitcnt vmcnt(7)
  s_cmp_ge_u32 s62, 30
  s_cbranch_scc1 L_cw19
  s_waitcnt vmcnt(6)
  s_cmp_ge_u32 s62, 26
  s_cbranch_scc1 L_cw19
  s_waitcnt vmcnt(5)
  s_cmp_ge_u32 s62, 22
  s_cbranch_scc1 L_cw19
  s_waitcnt vmcnt(4)
  s_cmp_ge_u32 s62, 18
  s_cbranch_scc1 L_cw19
  s_waitcnt vmcnt(3)
L_cw19:
  buffer_load_dwordx4 v[120:123], v4, s[12:15], 0 offen nt
  v_dot2c_f32_bf16_dpp v48, v12, v72 row_newbcast:2 row_mask:0xf bank_mask:0xf
  v_dot2c_f32_bf16_dpp v49, v13, v72 row_newbcast:2 row_mask:0xf bank_mask:0xf
  v_dot2c_f32_bf16_dpp v50, v12, v73 row_newbcast:2 row_mask:0xf bank_mask:0xf
  v_dot2c_f32_bf16_dpp v51, v13, v73 row_newbcast:2 row_mask:0xf bank_mask:0xf
  v_dot2c_f32_bf16_dpp v52, v12, v74 row_newbcast:2 row_mask:0xf bank_mask:0xf
  v_dot2c_f32_bf16_dpp v53, v13, v74 row_newbcast:2 row_mask:0xf bank_mask:0xf
  v_dot2c_f32_bf16_dpp v54, v12, v75 row_newbcast:2 row_mask:0xf bank_mask:0xf
  v_dot2c_f32_bf16_dpp v55, v13, v75 row_newbcast:2 row_mask:0xf bank_mask:0xf
  ds_add_u32 v19, v56 offset:11776
  s_waitcnt lgkmcnt(1)
  v_readfirstlane_b32 s62, v61
  v_xor_b32 v4, 0x58500, v58
  s_cmp_gt_i32 s61, 3
  s_cbranch_scc0 L_dr3
  s_waitcnt vmcnt(11)
  s_cmp_ge_u32 s62, 45
  s_cbranch_scc1 L_cw20
  s_waitcnt vmcnt(9)
  s_cmp_ge_u32 s62, 37
  s_cbranch_scc1 L_cw20
  s_waitcnt vmcnt(7)
  s_cmp_ge_u32 s62, 29
  s_cbranch_scc1 L_cw20
  s_waitcnt vmcnt(6)
  s_cmp_ge_u32 s62, 25
  s_cbranch_scc1 L_cw20
  s_waitcnt vmcnt(5)
  s_cmp_ge_u32 s62, 21
  s_cbranch_scc1 L_cw20
  s_waitcnt vmcnt(4)
  s_cmp_ge_u32 s62, 17
  s_cbranch_scc1 L_cw20
  s_waitcnt vmcnt(3)
L_cw20:
  buffer_load_dwordx4 v[124:127], v4, s[12:15], 0 offen nt
  v_dot2c_f32_bf16_dpp v48, v12, v76 row_newbcast:3 row_mask:0xf bank_mask:0xf
  v_dot2c_f32_bf16_dpp v49, v13, v76 row_newbcast:3 row_mask:0xf bank_mask:0xf
  v_dot2c_f32_bf16_dpp v50, v12, v77 row_newbcast:3 row_mask:0xf bank_mask:0xf
  v_dot2c_f32_bf16_dpp v51, v13, v77 row_newbcast:3 row_mask:0xf bank_mask:0xf
  v_dot2c_f32_bf16_dpp v52, v12, v78 row_newbcast:3 row_mask:0xf bank_mask:0xf
  v_dot2c_f32_bf16_dpp v53, v13, v78 row_newbcast:3 row_mask:0xf bank_mask:0xf
  v_dot2c_f32_bf16_dpp v54, v12, v79 row_newbcast:3 row_mask:0xf bank_mask:0xf
  v_dot2c_f32_bf16_dpp v55, v13, v79 row_newbcast:3 row_mask:0xf bank_mask:0xf
  ds_read_b32 v61, v59 offset:8720
  s_add_u32 s42, s54, 1
  s_bitcmp1_b32 s42, 0
  s_cselect_b32 s50, 0x40000, 0
  s_bitcmp1_b32 s42, 1
  s_cselect_b32 s6, 0x20c00, 0
  s_xor_b32 s50, s50, s6
  s_bitcmp1_b32 s42, 2
  s_cselect_b32 s6, 0x20400, 0
  s_xor_b32 s50, s50, s6
  v_xor_b32 v58, s50, v5
  s_sub_u32 s42, s54, 6
  s_cmp_gt_u32 s42, 1
  s_cbranch_scc1 L_nodec
  s_lshl_b32 s42, s42, 2
  v_mov_b32 v4, s42
  s_mov_b32 s55, 262144
L_sp_dec:
  ds_read_b32 v57, v4 offset:8640
  s_waitcnt lgkmcnt(0)
  v_readfirstlane_b32 s61, v57
  s_cmp_lg_u32 s61, -1
  s_cbranch_scc1 L_sp_dec_done
  s_sleep 1
  s_sub_u32 s55, s55, 1
  s_cmp_lg_u32 s55, 0
  s_cbranch_scc1 L_sp_dec
L_sp_dec_done:
  s_max_i32 s61, s61, 112
  s_min_i32 s61, s61, 144
  s_lshl_b32 s43, s54, 4
  s_add_u32 s43, s43, 12
  s_sub_u32 s61, s61, s43
  s_cmp_lg_u32 s54, 7
  s_cbranch_scc1 L_nodec
  v_xor_b32 v58, 0xf8d00, v5
  v_xor_b32 v4, 60, v18
  ds_read_b32 v40, v4 offset:12032
L_nodec:
  s_cmp_gt_i32 s61, 4
  s_cbranch_scc0 L_dr4
  s_waitcnt vmcnt(11)
  s_cmp_ge_u32 s62, 48
  s_cbranch_scc1 L_cw21
  s_waitcnt vmcnt(9)
  s_cmp_ge_u32 s62, 40
  s_cbranch_scc1 L_cw21
  s_waitcnt vmcnt(7)
  s_cmp_ge_u32 s62, 32
  s_cbranch_scc1 L_cw21
  s_waitcnt vmcnt(6)
  s_cmp_ge_u32 s62, 28
  s_cbranch_scc1 L_cw21
  s_waitcnt vmcnt(5)
  s_cmp_ge_u32 s62, 24
  s_cbranch_scc1 L_cw21
  s_waitcnt vmcnt(4)
  s_cmp_ge_u32 s62, 20
  s_cbranch_scc1 L_cw21
  s_waitcnt vmcnt(3)
L_cw21:
  buffer_load_dwordx4 v[64:67], v58, s[12:15], 0 offen nt
  v_dot2c_f32_bf16_dpp v48, v12, v80 row_newbcast:4 row_mask:0xf bank_mask:0xf
  v_dot2c_f32_bf16_dpp v49, v13, v80 row_newbcast:4 row_mask:0xf bank_mask:0xf
  v_dot2c_f32_bf16_dpp v50, v12, v81 row_newbcast:4 row_mask:0xf bank_mask:0xf
  v_dot2c_f32_bf16_dpp v51, v13, v81 row_newbcast:4 row_mask:0xf bank_mask:0xf
  v_dot2c_f32_bf16_dpp v52, v12, v82 row_newbcast:4 row_mask:0xf bank_mask:0xf
  v_dot2c_f32_bf16_dpp v53, v13, v82 row_newbcast:4 row_mask:0xf bank_mask:0xf
  v_dot2c_f32_bf16_dpp v54, v12, v83 row_newbcast:4 row_mask:0xf bank_mask:0xf
  v_dot2c_f32_bf16_dpp v55, v13, v83 row_newbcast:4 row_mask:0xf bank_mask:0xf
  ds_add_u32 v19, v56 offset:11776
  s_waitcnt lgkmcnt(1)
  v_readfirstlane_b32 s62, v61
  v_xor_b32 v4, 0x8100, v58
  s_cmp_gt_i32 s61, 5
  s_cbranch_scc0 L_dr5
  s_waitcnt vmcnt(11)
  s_cmp_ge_u32 s62, 47
  s_cbranch_scc1 L_cw22
  s_waitcnt vmcnt(9)
  s_cmp_ge_u32 s62, 39
  s_cbranch_scc1 L_cw22
  s_waitcnt vmcnt(7)
  s_cmp_ge_u32 s62, 31
  s_cbranch_scc1 L_cw22
  s_waitcnt vmcnt(6)
  s_cmp_ge_u32 s62, 27
  s_cbranch_scc1 L_cw22
  s_waitcnt vmcnt(5)
  s_cmp_ge_u32 s62, 23
  s_cbranch_scc1 L_cw22
  s_waitcnt vmcnt(4)
  s_cmp_ge_u32 s62, 19
  s_cbranch_scc1 L_cw22
  s_waitcnt vmcnt(3)
L_cw22:
  buffer_load_dwordx4 v[68:71], v4, s[12:15], 0 offen nt
  v_dot2c_f32_bf16_dpp v48, v12, v84 row_newbcast:5 row_mask:0xf bank_mask:0xf
  v_dot2c_f32_bf16_dpp v49, v13, v84 row_newbcast:5 row_mask:0xf bank_mask:0xf
  v_dot2c_f32_bf16_dpp v50, v12, v85 row_newbcast:5 row_mask:0xf bank_mask:0xf
  v_dot2c_f32_bf16_dpp v51, v13, v85 row_newbcast:5 row_mask:0xf bank_mask:0xf
  v_dot2c_f32_bf16_dpp v52, v12, v86 row_newbcast:5 row_mask:0xf bank_mask:0xf
  v_dot2c_f32_bf16_dpp v53, v13, v86 row_newbcast:5 row_mask:0xf bank_mask:0xf
  v_dot2c_f32_bf16_dpp v54, v12, v87 row_newbcast:5 row_mask:0xf bank_mask:0xf
  v_dot2c_f32_bf16_dpp v55, v13, v87 row_newbcast:5 row_mask:0xf bank_mask:0xf
  ds_read_b32 v61, v59 offset:8720
  v_xor_b32 v4, 0x84c00, v58
  s_cmp_gt_i32 s61, 6
  s_cbranch_scc0 L_dr6
  s_waitcnt vmcnt(11)
  s_cmp_ge_u32 s62, 46
  s_cbranch_scc1 L_cw23
  s_waitcnt vmcnt(9)
  s_cmp_ge_u32 s62, 38
  s_cbranch_scc1 L_cw23
  s_waitcnt vmcnt(7)
  s_cmp_ge_u32 s62, 30
  s_cbranch_scc1 L_cw23
  s_waitcnt vmcnt(6)
  s_cmp_ge_u32 s62, 26
  s_cbranch_scc1 L_cw23
  s_waitcnt vmcnt(5)
  s_cmp_ge_u32 s62, 22
  s_cbranch_scc1 L_cw23
  s_waitcnt vmcnt(4)
  s_cmp_ge_u32 s62, 18
  s_cbranch_scc1 L_cw23
  s_waitcnt vmcnt(3)
L_cw23:
  buffer_load_dwordx4 v[72:75], v4, s[12:15], 0 offen nt
  v_dot2c_f32_bf16_dpp v48, v12, v88 row_newbcast:6 row_mask:0xf bank_mask:0xf
  v_dot2c_f32_bf16_dpp v49, v13, v88 row_newbcast:6 row_mask:0xf bank_mask:0xf
  v_dot2c_f32_bf16_dpp v50, v12, v89 row_newbcast:6 row_mask:0xf bank_mask:0xf
  v_dot2c_f32_bf16_dpp v51, v13, v89 row_newbcast:6 row_mask:0xf bank_mask:0xf
  v_dot2c_f32_bf16_dpp v52, v12, v90 row_newbcast:6 row_mask:0xf bank_mask:0xf
  v_dot2c_f32_bf16_dpp v53, v13, v90 row_newbcast:6 row_mask:0xf bank_mask:0xf
  v_dot2c_f32_bf16_dpp v54, v12, v91 row_newbcast:6 row_mask:0xf bank_mask:0xf
  v_dot2c_f32_bf16_dpp v55, v13, v91 row_newbcast:6 row_mask:0xf bank_mask:0xf
  ds_add_u32 v19, v56 offset:11776
  s_waitcnt lgkmcnt(1)
  v_readfirstlane_b32 s62, v61
  v_xor_b32 v4, 0x8cd00, v58
  s_cmp_gt_i32 s61, 7
  s_cbranch_scc0 L_dr7
  s_waitcnt vmcnt(11)
  s_cmp_ge_u32 s62, 45
  s_cbranch_scc1 L_cw24
  s_waitcnt vmcnt(9)
  s_cmp_ge_u32 s62, 37
  s_cbranch_scc1 L_cw24
  s_waitcnt vmcnt(7)
  s_cmp_ge_u32 s62, 29
  s_cbranch_scc1 L_cw24
  s_waitcnt vmcnt(6)
  s_cmp_ge_u32 s62, 25
  s_cbranch_scc1 L_cw24
  s_waitcnt vmcnt(5)
  s_cmp_ge_u32 s62, 21
  s_cbranch_scc1 L_cw24
  s_waitcnt vmcnt(4)
  s_cmp_ge_u32 s62, 17
  s_cbranch_scc1 L_cw24
  s_waitcnt vmcnt(3)
L_cw24:
  buffer_load_dwordx4 v[76:79], v4, s[12:15], 0 offen nt
  v_dot2c_f32_bf16_dpp v48, v12, v92 row_newbcast:7 row_mask:0xf bank_mask:0xf
  v_dot2c_f32_bf16_dpp v49, v13, v92 row_newbcast:7 row_mask:0xf bank_mask:0xf
  v_dot2c_f32_bf16_dpp v50, v12, v93 row_newbcast:7 row_mask:0xf bank_mask:0xf
  v_dot2c_f32_bf16_dpp v51, v13, v93 row_newbcast:7 row_mask:0xf bank_mask:0xf
  v_dot2c_f32_bf16_dpp v52, v12, v94 row_newbcast:7 row_mask:0xf bank_mask:0xf
  v_dot2c_f32_bf16_dpp v53, v13, v94 row_newbcast:7 row_mask:0xf bank_mask:0xf
  v_dot2c_f32_bf16_dpp v54, v12, v95 row_newbcast:7 row_mask:0xf bank_mask:0xf
  v_dot2c_f32_bf16_dpp v55, v13, v95 row_newbcast:7 row_mask:0xf bank_mask:0xf
  ds_read_b32 v61, v59 offset:8720
  v_xor_b32 v4, 0x400, v58
  s_cmp_gt_i32 s61, 8
  s_cbranch_scc0 L_dr8
  s_waitcnt vmcnt(11)
  s_cmp_ge_u32 s62, 48
  s_cbranch_scc1 L_cw25
  s_waitcnt vmcnt(9)
  s_cmp_ge_u32 s62, 40
  s_cbranch_scc1 L_cw25
  s_waitcnt vmcnt(7)
  s_cmp_ge_u32 s62, 32
  s_cbranch_scc1 L_cw25
  s_waitcnt vmcnt(6)
  s_cmp_ge_u32 s62, 28
  s_cbranch_scc1 L_cw25
  s_waitcnt vmcnt(5)
  s_cmp_ge_u32 s62, 24
  s_cbranch_scc1 L_cw25
  s_waitcnt vmcnt(4)
  s_cmp_ge_u32 s62, 20
  s_cbranch_scc1 L_cw25
  s_waitcnt vmcnt(3)
L_cw25:
  buffer_load_dwordx4 v[80:83], v4, s[12:15], 0 offen nt
  v_dot2c_f32_bf16_dpp v48, v12, v96 row_newbcast:8 row_mask:0xf bank_mask:0xf
  v_dot2c_f32_bf16_dpp v49, v13, v96 row_newbcast:8 row_mask:0xf bank_mask:0xf
  v_dot2c_f32_bf16_dpp v50, v12, v97 row_newbcast:8 row_mask:0xf bank_mask:0xf
  v_dot2c_f32_bf16_dpp v51, v13, v97 row_newbcast:8 row_mask:0xf bank_mask:0xf
  v_dot2c_f32_bf16_dpp v52, v12, v98 row_newbcast:8 row_mask:0xf bank_mask:0xf
  v_dot2c_f32_bf16_dpp v53, v13, v98 row_newbcast:8 row_mask:0xf bank_mask:0xf
  v_dot2c_f32_bf16_dpp v54, v12, v99 row_newbcast:8 row_mask:0xf bank_mask:0xf
  v_dot2c_f32_bf16_dpp v55, v13, v99 row_newbcast:8 row_mask:0xf bank_mask:0xf
  ds_add_u32 v19, v56 offset:11776
  s_waitcnt lgkmcnt(1)
  v_readfirstlane_b32 s62, v61
  v_xor_b32 v4, 0x8500, v58
  s_cmp_gt_i32 s61, 9
  s_cbranch_scc0 L_dr9
  s_waitcnt vmcnt(11)
  s_cmp_ge_u32 s62, 47
  s_cbranch_scc1 L_cw26
  s_waitcnt vmcnt(9)
  s_cmp_ge_u32 s62, 39
  s_cbranch_scc1 L_cw26
  s_waitcnt vmcnt(7)
  s_cmp_ge_u32 s62, 31
  s_cbranch_scc1 L_cw26
  s_waitcnt vmcnt(6)
  s_cmp_ge_u32 s62, 27
  s_cbranch_scc1 L_cw26
  s_waitcnt vmcnt(5)
  s_cmp_ge_u32 s62, 23
  s_cbranch_scc1 L_cw26
  s_waitcnt vmcnt(4)
  s_cmp_ge_u32 s62, 19
  s_cbranch_scc1 L_cw26
  s_waitcnt vmcnt(3)
L_cw26:
  buffer_load_dwordx4 v[84:87], v4, s[12:15], 0 offen nt
  v_dot2c_f32_bf16_dpp v48, v12, v100 row_newbcast:9 row_mask:0xf bank_mask:0xf
  v_dot2c_f32_bf16_dpp v49, v13, v100 row_newbcast:9 row_mask:0xf bank_mask:0xf
  v_dot2c_f32_bf16_dpp v50, v12, v101 row_newbcast:9 row_mask:0xf bank_mask:0xf
  v_dot2c_f32_bf16_dpp v51, v13, v101 row_newbcast:9 row_mask:0xf bank_mask:0xf
  v_dot2c_f32_bf16_dpp v52, v12, v102 row_newbcast:9 row_mask:0xf bank_mask:0xf
  v_dot2c_f32_bf16_dpp v53, v13, v102 row_newbcast:9 row_mask:0xf bank_mask:0xf
  v_dot2c_f32_bf16_dpp v54, v12, v103 row_newbcast:9 row_mask:0xf bank_mask:0xf
  v_dot2c_f32_bf16_dpp v55, v13, v103 row_newbcast:9 row_mask:0xf bank_mask:0xf
  ds_read_b32 v61, v59 offset:8720
  v_xor_b32 v4, 0x84800, v58
  s_cmp_gt_i32 s61, 10
  s_cbranch_scc0 L_dr10
  s_waitcnt vmcnt(11)
  s_cmp_ge_u32 s62, 46
  s_cbranch_scc1 L_cw27
  s_waitcnt vmcnt(9)
  s_cmp_ge_u32 s62, 38
  s_cbranch_scc1 L_cw27
  s_waitcnt vmcnt(7)
  s_cmp_ge_u32 s62, 30
  s_cbranch_scc1 L_cw27
  s_waitcnt vmcnt(6)
  s_cmp_ge_u32 s62, 26
  s_cbranch_scc1 L_cw27
  s_waitcnt vmcnt(5)
  s_cmp_ge_u32 s62, 22
  s_cbranch_scc1 L_cw27
  s_waitcnt vmcnt(4)
  s_cmp_ge_u32 s62, 18
  s_cbranch_scc1 L_cw27
  s_waitcnt vmcnt(3)
L_cw27:
  buffer_load_dwordx4 v[88:91], v4, s[12:15], 0 offen nt
  v_dot2c_f32_bf16_dpp v48, v12, v104 row_newbcast:10 row_mask:0xf bank_mask:0xf
  v_dot2c_f32_bf16_dpp v49, v13, v104 row_newbcast:10 row_mask:0xf bank_mask:0xf
  v_dot2c_f32_bf16_dpp v50, v12, v105 row_newbcast:10 row_mask:0xf bank_mask:0xf
  v_dot2c_f32_bf16_dpp v51, v13, v105 row_newbcast:10 row_mask:0xf bank_mask:0xf
  v_dot2c_f32_bf16_dpp v52, v12, v106 row_newbcast:10 row_mask:0xf bank_mask:0xf
  v_dot2c_f32_bf16_dpp v53, v13, v106 row_newbcast:10 row_mask:0xf bank_mask:0xf
  v_dot2c_f32_bf16_dpp v54, v12, v107 row_newbcast:10 row_mask:0xf bank_mask:0xf
  v_dot2c_f32_bf16_dpp v55, v13, v107 row_newbcast:10 row_mask:0xf bank_mask:0xf
  ds_add_u32 v19, v56 offset:11776
  s_waitcnt lgkmcnt(1)
  v_readfirstlane_b32 s62, v61
  v_xor_b32 v4, 0x8c900, v58
  s_cmp_gt_i32 s61, 11
  s_cbranch_scc0 L_dr11
  s_waitcnt vmcnt(11)
  s_cmp_ge_u32 s62, 45
  s_cbranch_scc1 L_cw28
  s_waitcnt vmcnt(9)
  s_cmp_ge_u32 s62, 37
  s_cbranch_scc1 L_cw28
  s_waitcnt vmcnt(7)
  s_cmp_ge_u32 s62, 29
  s_cbranch_scc1 L_cw28
  s_waitcnt vmcnt(6)
  s_cmp_ge_u32 s62, 25
  s_cbranch_scc1 L_cw28
  s_waitcnt vmcnt(5)
  s_cmp_ge_u32 s62, 21
  s_cbranch_scc1 L_cw28
  s_waitcnt vmcnt(4)
  s_cmp_ge_u32 s62, 17
  s_cbranch_scc1 L_cw28
  s_waitcnt vmcnt(3)
L_cw28:
  buffer_load_dwordx4 v[92:95], v4, s[12:15], 0 offen nt
  v_dot2c_f32_bf16_dpp v48, v12, v108 row_newbcast:11 row_mask:0xf bank_mask:0xf
  v_dot2c_f32_bf16_dpp v49, v13, v108 row_newbcast:11 row_mask:0xf bank_mask:0xf
  v_dot2c_f32_bf16_dpp v50, v12, v109 row_newbcast:11 row_mask:0xf bank_mask:0xf
  v_dot2c_f32_bf16_dpp v51, v13, v109 row_newbcast:11 row_mask:0xf bank_mask:0xf
  v_dot2c_f32_bf16_dpp v52, v12, v110 row_newbcast:11 row_mask:0xf bank_mask:0xf
  v_dot2c_f32_bf16_dpp v53, v13, v110 row_newbcast:11 row_mask:0xf bank_mask:0xf
  v_dot2c_f32_bf16_dpp v54, v12, v111 row_newbcast:11 row_mask:0xf bank_mask:0xf
  v_dot2c_f32_bf16_dpp v55, v13, v111 row_newbcast:11 row_mask:0xf bank_mask:0xf
  ds_read_b32 v61, v59 offset:8720
  v_xor_b32 v4, 0xd4c00, v58
  s_cmp_gt_i32 s61, 12
  s_cbranch_scc0 L_dr12
  s_waitcnt vmcnt(11)
  s_cmp_ge_u32 s62, 48
  s_cbranch_scc1 L_cw29
  s_waitcnt vmcnt(9)
  s_cmp_ge_u32 s62, 40
  s_cbranch_scc1 L_cw29
  s_waitcnt vmcnt(7)
  s_cmp_ge_u32 s62, 32
  s_cbranch_scc1 L_cw29
  s_waitcnt vmcnt(6)
  s_cmp_ge_u32 s62, 28
  s_cbranch_scc1 L_cw29
  s_waitcnt vmcnt(5)
  s_cmp_ge_u32 s62, 24
  s_cbranch_scc1 L_cw29
  s_waitcnt vmcnt(4)
  s_cmp_ge_u32 s62, 20
  s_cbranch_scc1 L_cw29
  s_waitcnt vmcnt(3)
L_cw29:
  buffer_load_dwordx4 v[96:99], v4, s[12:15], 0 offen nt
  v_dot2c_f32_bf16_dpp v48, v12, v112 row_newbcast:12 row_mask:0xf bank_mask:0xf
  v_dot2c_f32_bf16_dpp v49, v13, v112 row_newbcast:12 row_mask:0xf bank_mask:0xf
  v_dot2c_f32_bf16_dpp v50, v12, v113 row_newbcast:12 row_mask:0xf bank_mask:0xf
  v_dot2c_f32_bf16_dpp v51, v13, v113 row_newbcast:12 row_mask:0xf bank_mask:0xf
  v_dot2c_f32_bf16_dpp v52, v12, v114 row_newbcast:12 row_mask:0xf bank_mask:0xf
  v_dot2c_f32_bf16_dpp v53, v13, v114 row_newbcast:12 row_mask:0xf bank_mask:0xf
  v_dot2c_f32_bf16_dpp v54, v12, v115 row_newbcast:12 row_mask:0xf bank_mask:0xf
  v_dot2c_f32_bf16_dpp v55, v13, v115 row_newbcast:12 row_mask:0xf bank_mask:0xf
  ds_add_u32 v19, v56 offset:11776
  s_waitcnt lgkmcnt(1)
  v_readfirstlane_b32 s62, v61
  v_xor_b32 v4, 0xdcd00, v58
  s_cmp_gt_i32 s61, 13
  s_cbranch_scc0 L_dr13
  s_waitcnt vmcnt(11)
  s_cmp_ge_u32 s62, 47
  s_cbranch_scc1 L_cw30
  s_waitcnt vmcnt(9)
  s_cmp_ge_u32 s62, 39
  s_cbranch_scc1 L_cw30
  s_waitcnt vmcnt(7)
  s_cmp_ge_u32 s62, 31
  s_cbranch_scc1 L_cw30
  s_waitcnt vmcnt(6)
  s_cmp_ge_u32 s62, 27
  s_cbranch_scc1 L_cw30
  s_waitcnt vmcnt(5)
  s_cmp_ge_u32 s62, 23
  s_cbranch_scc1 L_cw30
  s_waitcnt vmcnt(4)
  s_cmp_ge_u32 s62, 19
  s_cbranch_scc1 L_cw30
  s_waitcnt vmcnt(3)
L_cw30:
  buffer_load_dwordx4 v[100:103], v4, s[12:15], 0 offen nt
  v_dot2c_f32_bf16_dpp v48, v12, v116 row_newbcast:13 row_mask:0xf bank_mask:0xf
  v_dot2c_f32_bf16_dpp v49, v13, v116 row_newbcast:13 row_mask:0xf bank_mask:0xf
  v_dot2c_f32_bf16_dpp v50, v12, v117 row_newbcast:13 row_mask:0xf bank_mask:0xf
  v_dot2c_f32_bf16_dpp v51, v13, v117 row_newbcast:13 row_mask:0xf bank_mask:0xf
  v_dot2c_f32_bf16_dpp v52, v12, v118 row_newbcast:13 row_mask:0xf bank_mask:0xf
  v_dot2c_f32_bf16_dpp v53, v13, v118 row_newbcast:13 row_mask:0xf bank_mask:0xf
  v_dot2c_f32_bf16_dpp v54, v12, v119 row_newbcast:13 row_mask:0xf bank_mask:0xf
  v_dot2c_f32_bf16_dpp v55, v13, v119 row_newbcast:13 row_mask:0xf bank_mask:0xf
  ds_read_b32 v61, v59 offset:8720
  v_xor_b32 v4, 0x50000, v58
  s_cmp_gt_i32 s61, 14
  s_cbranch_scc0 L_dr14
  s_waitcnt vmcnt(11)
  s_cmp_ge_u32 s62, 46
  s_cbranch_scc1 L_cw31
  s_waitcnt vmcnt(9)
  s_cmp_ge_u32 s62, 38
  s_cbranch_scc1 L_cw31
  s_waitcnt vmcnt(7)
  s_cmp_ge_u32 s62, 30
  s_cbranch_scc1 L_cw31
  s_waitcnt vmcnt(6)
  s_cmp_ge_u32 s62, 26
  s_cbranch_scc1 L_cw31
  s_waitcnt vmcnt(5)
  s_cmp_ge_u32 s62, 22
  s_cbranch_scc1 L_cw31
  s_waitcnt vmcnt(4)
  s_cmp_ge_u32 s62, 18
  s_cbranch_scc1 L_cw31
  s_waitcnt vmcnt(3)
L_cw31:
  buffer_load_dwordx4 v[104:107], v4, s[12:15], 0 offen nt
  v_dot2c_f32_bf16_dpp v48, v12, v120 row_newbcast:14 row_mask:0xf bank_mask:0xf
  v_dot2c_f32_bf16_dpp v49, v13, v120 row_newbcast:14 row_mask:0xf bank_mask:0xf
  v_dot2c_f32_bf16_dpp v50, v12, v121 row_newbcast:14 row_mask:0xf bank_mask:0xf
  v_dot2c_f32_bf16_dpp v51, v13, v121 row_newbcast:14 row_mask:0xf bank_mask:0xf
  v_dot2c_f32_bf16_dpp v52, v12, v122 row_newbcast:14 row_mask:0xf bank_mask:0xf
  v_dot2c_f32_bf16_dpp v53, v13, v122 row_newbcast:14 row_mask:0xf bank_mask:0xf
  v_dot2c_f32_bf16_dpp v54, v12, v123 row_newbcast:14 row_mask:0xf bank_mask:0xf
  v_dot2c_f32_bf16_dpp v55, v13, v123 row_newbcast:14 row_mask:0xf bank_mask:0xf
  ds_add_u32 v19, v56 offset:11776
  s_waitcnt lgkmcnt(1)
  v_readfirstlane_b32 s62, v61
  v_xor_b32 v4, 0x58100, v58
  s_cmp_gt_i32 s61, 15
  s_cbranch_scc0 L_dr15
  s_waitcnt vmcnt(11)
  s_cmp_ge_u32 s62, 45
  s_cbranch_scc1 L_cw32
  s_waitcnt vmcnt(9)
  s_cmp_ge_u32 s62, 37
  s_cbranch_scc1 L_cw32
  s_waitcnt vmcnt(7)
  s_cmp_ge_u32 s62, 29
  s_cbranch_scc1 L_cw32
  s_waitcnt vmcnt(6)
  s_cmp_ge_u32 s62, 25
  s_cbranch_scc1 L_cw32
  s_waitcnt vmcnt(5)
  s_cmp_ge_u32 s62, 21
  s_cbranch_scc1 L_cw32
  s_waitcnt vmcnt(4)
  s_cmp_ge_u32 s62, 17
  s_cbranch_scc1 L_cw32
  s_waitcnt vmcnt(3)
L_cw32:
  buffer_load_dwordx4 v[108:111], v4, s[12:15], 0 offen nt
  v_dot2c_f32_bf16_dpp v48, v12, v124 row_newbcast:15 row_mask:0xf bank_mask:0xf
  v_dot2c_f32_bf16_dpp v49, v13, v124 row_newbcast:15 row_mask:0xf bank_mask:0xf
  v_dot2c_f32_bf16_dpp v50, v12, v125 row_newbcast:15 row_mask:0xf bank_mask:0xf
  v_dot2c_f32_bf16_dpp v51, v13, v125 row_newbcast:15 row_mask:0xf bank_mask:0xf
  v_dot2c_f32_bf16_dpp v52, v12, v126 row_newbcast:15 row_mask:0xf bank_mask:0xf
  v_dot2c_f32_bf16_dpp v53, v13, v126 row_newbcast:15 row_mask:0xf bank_mask:0xf
  v_dot2c_f32_bf16_dpp v54, v12, v127 row_newbcast:15 row_mask:0xf bank_mask:0xf
  v_dot2c_f32_bf16_dpp v55, v13, v127 row_newbcast:15 row_mask:0xf bank_mask:0xf
  ds_read_b32 v61, v59 offset:8720
  s_add_u32 s54, s54, 1
  s_sub_u32 s61, s61, 16
  s_branch L_vloop
L_drw:
  s_waitcnt lgkmcnt(0)
  v_cvt_pk_bf16_f32 v12, v40, 0
  v_cvt_pk_bf16_f32 v13, 0, v40
  s_sub_u32 s61, s61, 16
L_dr0:
  s_waitcnt vmcnt(11)
  buffer_load_dword v112, v4, s[12:15], s14 offen
  s_cmp_le_i32 s61, -11
  v_dot2c_f32_bf16_dpp v48, v12, v64 row_newbcast:0 row_mask:0xf bank_mask:0xf
  v_dot2c_f32_bf16_dpp v49, v13, v64 row_newbcast:0 row_mask:0xf bank_mask:0xf
  v_dot2c_f32_bf16_dpp v50, v12, v65 row_newbcast:0 row_mask:0xf bank_mask:0xf
  v_dot2c_f32_bf16_dpp v51, v13, v65 row_newbcast:0 row_mask:0xf bank_mask:0xf
  v_dot2c_f32_bf16_dpp v52, v12, v66 row_newbcast:0 row_mask:0xf bank_mask:0xf
  v_dot2c_f32_bf16_dpp v53, v13, v66 row_newbcast:0 row_mask:0xf bank_mask:0xf
  v_dot2c_f32_bf16_dpp v54, v12, v67 row_newbcast:0 row_mask:0xf bank_mask:0xf
  v_dot2c_f32_bf16_dpp v55, v13, v67 row_newbcast:0 row_mask:0xf bank_mask:0xf
  s_cbranch_scc1 L_vdone
L_dr1:
  s_waitcnt vmcnt(11)
  buffer_load_dword v116, v4, s[12:15], s14 offen
  s_cmp_le_i32 s61, -10
  v_dot2c_f32_bf16_dpp v48, v12, v68 row_newbcast:1 row_mask:0xf bank_mask:0xf
  v_dot2c_f32_bf16_dpp v49, v13, v68 row_newbcast:1 row_mask:0xf bank_mask:0xf
  v_dot2c_f32_bf16_dpp v50, v12, v69 row_newbcast:1 row_mask:0xf bank_mask:0xf
  v_dot2c_f32_bf16_dpp v51, v13, v69 row_newbcast:1 row_mask:0xf bank_mask:0xf
  v_dot2c_f32_bf16_dpp v52, v12, v70 row_newbcast:1 row_mask:0xf bank_mask:0xf
  v_dot2c_f32_bf16_dpp v53, v13, v70 row_newbcast:1 row_mask:0xf bank_mask:0xf
  v_dot2c_f32_bf16_dpp v54, v12, v71 row_newbcast:1 row_mask:0xf bank_mask:0xf
  v_dot2c_f32_bf16_dpp v55, v13, v71 row_newbcast:1 row_mask:0xf bank_mask:0xf
  s_cbranch_scc1 L_vdone
L_dr2:
  s_waitcnt vmcnt(11)
  buffer_load_dword v120, v4, s[12:15], s14 offen
  s_cmp_le_i32 s61, -9
  v_dot2c_f32_bf16_dpp v48, v12, v72 row_newbcast:2 row_mask:0xf bank_mask:0xf
  v_dot2c_f32_bf16_dpp v49, v13, v72 row_newbcast:2 row_mask:0xf bank_mask:0xf
  v_dot2c_f32_bf16_dpp v50, v12, v73 row_newbcast:2 row_mask:0xf bank_mask:0xf
  v_dot2c_f32_bf16_dpp v51, v13, v73 row_newbcast:2 row_mask:0xf bank_mask:0xf
  v_dot2c_f32_bf16_dpp v52, v12, v74 row_newbcast:2 row_mask:0xf bank_mask:0xf
  v_dot2c_f32_bf16_dpp v53, v13, v74 row_newbcast:2 row_mask:0xf bank_mask:0xf
  v_dot2c_f32_bf16_dpp v54, v12, v75 row_newbcast:2 row_mask:0xf bank_mask:0xf
  v_dot2c_f32_bf16_dpp v55, v13, v75 row_newbcast:2 row_mask:0xf bank_mask:0xf
  s_cbranch_scc1 L_vdone
L_dr3:
  s_waitcnt vmcnt(11)
  buffer_load_dword v124, v4, s[12:15], s14 offen
  s_cmp_le_i32 s61, -8
  v_dot2c_f32_bf16_dpp v48, v12, v76 row_newbcast:3 row_mask:0xf bank_mask:0xf
  v_dot2c_f32_bf16_dpp v49, v13, v76 row_newbcast:3 row_mask:0xf bank_mask:0xf
  v_dot2c_f32_bf16_dpp v50, v12, v77 row_newbcast:3 row_mask:0xf bank_mask:0xf
  v_dot2c_f32_bf16_dpp v51, v13, v77 row_newbcast:3 row_mask:0xf bank_mask:0xf
  v_dot2c_f32_bf16_dpp v52, v12, v78 row_newbcast:3 row_mask:0xf bank_mask:0xf
  v_dot2c_f32_bf16_dpp v53, v13, v78 row_newbcast:3 row_mask:0xf bank_mask:0xf
  v_dot2c_f32_bf16_dpp v54, v12, v79 row_newbcast:3 row_mask:0xf bank_mask:0xf
  v_dot2c_f32_bf16_dpp v55, v13, v79 row_newbcast:3 row_mask:0xf bank_mask:0xf
  s_cbranch_scc1 L_vdone
L_dr4:
  s_waitcnt vmcnt(11)
  buffer_load_dword v64, v4, s[12:15], s14 offen
  s_cmp_le_i32 s61, -7
  v_dot2c_f32_bf16_dpp v48, v12, v80 row_newbcast:4 row_mask:0xf bank_mask:0xf
  v_dot2c_f32_bf16_dpp v49, v13, v80 row_newbcast:4 row_mask:0xf bank_mask:0xf
  v_dot2c_f32_bf16_dpp v50, v12, v81 row_newbcast:4 row_mask:0xf bank_mask:0xf
  v_dot2c_f32_bf16_dpp v51, v13, v81 row_newbcast:4 row_mask:0xf bank_mask:0xf
  v_dot2c_f32_bf16_dpp v52, v12, v82 row_newbcast:4 row_mask:0xf bank_mask:0xf
  v_dot2c_f32_bf16_dpp v53, v13, v82 row_newbcast:4 row_mask:0xf bank_mask:0xf
  v_dot2c_f32_bf16_dpp v54, v12, v83 row_newbcast:4 row_mask:0xf bank_mask:0xf
  v_dot2c_f32_bf16_dpp v55, v13, v83 row_newbcast:4 row_mask:0xf bank_mask:0xf
  s_cbranch_scc1 L_vdone
L_dr5:
  s_waitcnt vmcnt(11)
  buffer_load_dword v68, v4, s[12:15], s14 offen
  s_cmp_le_i32 s61, -6
  v_dot2c_f32_bf16_dpp v48, v12, v84 row_newbcast:5 row_mask:0xf bank_mask:0xf
  v_dot2c_f32_bf16_dpp v49, v13, v84 row_newbcast:5 row_mask:0xf bank_mask:0xf
  v_dot2c_f32_bf16_dpp v50, v12, v85 row_newbcast:5 row_mask:0xf bank_mask:0xf
  v_dot2c_f32_bf16_dpp v51, v13, v85 row_newbcast:5 row_mask:0xf bank_mask:0xf
  v_dot2c_f32_bf16_dpp v52, v12, v86 row_newbcast:5 row_mask:0xf bank_mask:0xf
  v_dot2c_f32_bf16_dpp v53, v13, v86 row_newbcast:5 row_mask:0xf bank_mask:0xf
  v_dot2c_f32_bf16_dpp v54, v12, v87 row_newbcast:5 row_mask:0xf bank_mask:0xf
  v_dot2c_f32_bf16_dpp v55, v13, v87 row_newbcast:5 row_mask:0xf bank_mask:0xf
  s_cbranch_scc1 L_vdone
L_dr6:
  s_waitcnt vmcnt(11)
  buffer_load_dword v72, v4, s[12:15], s14 offen
  s_cmp_le_i32 s61, -5
  v_dot2c_f32_bf16_dpp v48, v12, v88 row_newbcast:6 row_mask:0xf bank_mask:0xf
  v_dot2c_f32_bf16_dpp v49, v13, v88 row_newbcast:6 row_mask:0xf bank_mask:0xf
  v_dot2c_f32_bf16_dpp v50, v12, v89 row_newbcast:6 row_mask:0xf bank_mask:0xf
  v_dot2c_f32_bf16_dpp v51, v13, v89 row_newbcast:6 row_mask:0xf bank_mask:0xf
  v_dot2c_f32_bf16_dpp v52, v12, v90 row_newbcast:6 row_mask:0xf bank_mask:0xf
  v_dot2c_f32_bf16_dpp v53, v13, v90 row_newbcast:6 row_mask:0xf bank_mask:0xf
  v_dot2c_f32_bf16_dpp v54, v12, v91 row_newbcast:6 row_mask:0xf bank_mask:0xf
  v_dot2c_f32_bf16_dpp v55, v13, v91 row_newbcast:6 row_mask:0xf bank_mask:0xf
  s_cbranch_scc1 L_vdone
L_dr7:
  s_waitcnt vmcnt(11)
  buffer_load_dword v76, v4, s[12:15], s14 offen
  s_cmp_le_i32 s61, -4
  v_dot2c_f32_bf16_dpp v48, v12, v92 row_newbcast:7 row_mask:0xf bank_mask:0xf
  v_dot2c_f32_bf16_dpp v49, v13, v92 row_newbcast:7 row_mask:0xf bank_mask:0xf
  v_dot2c_f32_bf16_dpp v50, v12, v93 row_newbcast:7 row_mask:0xf bank_mask:0xf
  v_dot2c_f32_bf16_dpp v51, v13, v93 row_newbcast:7 row_mask:0xf bank_mask:0xf
  v_dot2c_f32_bf16_dpp v52, v12, v94 row_newbcast:7 row_mask:0xf bank_mask:0xf
  v_dot2c_f32_bf16_dpp v53, v13, v94 row_newbcast:7 row_mask:0xf bank_mask:0xf
  v_dot2c_f32_bf16_dpp v54, v12, v95 row_newbcast:7 row_mask:0xf bank_mask:0xf
  v_dot2c_f32_bf16_dpp v55, v13, v95 row_newbcast:7 row_mask:0xf bank_mask:0xf
  s_cbranch_scc1 L_vdone
L_dr8:
  s_waitcnt vmcnt(11)
  buffer_load_dword v80, v4, s[12:15], s14 offen
  s_cmp_le_i32 s61, -3
  v_dot2c_f32_bf16_dpp v48, v12, v96 row_newbcast:8 row_mask:0xf bank_mask:0xf
  v_dot2c_f32_bf16_dpp v49, v13, v96 row_newbcast:8 row_mask:0xf bank_mask:0xf
  v_dot2c_f32_bf16_dpp v50, v12, v97 row_newbcast:8 row_mask:0xf bank_mask:0xf
  v_dot2c_f32_bf16_dpp v51, v13, v97 row_newbcast:8 row_mask:0xf bank_mask:0xf
  v_dot2c_f32_bf16_dpp v52, v12, v98 row_newbcast:8 row_mask:0xf bank_mask:0xf
  v_dot2c_f32_bf16_dpp v53, v13, v98 row_newbcast:8 row_mask:0xf bank_mask:0xf
  v_dot2c_f32_bf16_dpp v54, v12, v99 row_newbcast:8 row_mask:0xf bank_mask:0xf
  v_dot2c_f32_bf16_dpp v55, v13, v99 row_newbcast:8 row_mask:0xf bank_mask:0xf
  s_cbranch_scc1 L_vdone
L_dr9:
  s_waitcnt vmcnt(11)
  buffer_load_dword v84, v4, s[12:15], s14 offen
  s_cmp_le_i32 s61, -2
  v_dot2c_f32_bf16_dpp v48, v12, v100 row_newbcast:9 row_mask:0xf bank_mask:0xf
  v_dot2c_f32_bf16_dpp v49, v13, v100 row_newbcast:9 row_mask:0xf bank_mask:0xf
  v_dot2c_f32_bf16_dpp v50, v12, v101 row_newbcast:9 row_mask:0xf bank_mask:0xf
  v_dot2c_f32_bf16_dpp v51, v13, v101 row_newbcast:9 row_mask:0xf bank_mask:0xf
  v_dot2c_f32_bf16_dpp v52, v12, v102 row_newbcast:9 row_mask:0xf bank_mask:0xf
  v_dot2c_f32_bf16_dpp v53, v13, v102 row_newbcast:9 row_mask:0xf bank_mask:0xf
  v_dot2c_f32_bf16_dpp v54, v12, v103 row_newbcast:9 row_mask:0xf bank_mask:0xf
  v_dot2c_f32_bf16_dpp v55, v13, v103 row_newbcast:9 row_mask:0xf bank_mask:0xf
  s_cbranch_scc1 L_vdone
L_dr10:
  s_waitcnt vmcnt(11)
  buffer_load_dword v88, v4, s[12:15], s14 offen
  s_cmp_le_i32 s61, -1
  v_dot2c_f32_bf16_dpp v48, v12, v104 row_newbcast:10 row_mask:0xf bank_mask:0xf
  v_dot2c_f32_bf16_dpp v49, v13, v104 row_newbcast:10 row_mask:0xf bank_mask:0xf
  v_dot2c_f32_bf16_dpp v50, v12, v105 row_newbcast:10 row_mask:0xf bank_mask:0xf
  v_dot2c_f32_bf16_dpp v51, v13, v105 row_newbcast:10 row_mask:0xf bank_mask:0xf
  v_dot2c_f32_bf16_dpp v52, v12, v106 row_newbcast:10 row_mask:0xf bank_mask:0xf
  v_dot2c_f32_bf16_dpp v53, v13, v106 row_newbcast:10 row_mask:0xf bank_mask:0xf
  v_dot2c_f32_bf16_dpp v54, v12, v107 row_newbcast:10 row_mask:0xf bank_mask:0xf
  v_dot2c_f32_bf16_dpp v55, v13, v107 row_newbcast:10 row_mask:0xf bank_mask:0xf
  s_cbranch_scc1 L_vdone
L_dr11:
  s_waitcnt vmcnt(11)
  buffer_load_dword v92, v4, s[12:15], s14 offen
  s_cmp_le_i32 s61, 0
  v_dot2c_f32_bf16_dpp v48, v12, v108 row_newbcast:11 row_mask:0xf bank_mask:0xf
  v_dot2c_f32_bf16_dpp v49, v13, v108 row_newbcast:11 row_mask:0xf bank_mask:0xf
  v_dot2c_f32_bf16_dpp v50, v12, v109 row_newbcast:11 row_mask:0xf bank_mask:0xf
  v_dot2c_f32_bf16_dpp v51, v13, v109 row_newbcast:11 row_mask:0xf bank_mask:0xf
  v_dot2c_f32_bf16_dpp v52, v12, v110 row_newbcast:11 row_mask:0xf bank_mask:0xf
  v_dot2c_f32_bf16_dpp v53, v13, v110 row_newbcast:11 row_mask:0xf bank_mask:0xf
  v_dot2c_f32_bf16_dpp v54, v12, v111 row_newbcast:11 row_mask:0xf bank_mask:0xf
  v_dot2c_f32_bf16_dpp v55, v13, v111 row_newbcast:11 row_mask:0xf bank_mask:0xf
  s_cbranch_scc1 L_vdone
L_dr12:
  s_waitcnt vmcnt(11)
  buffer_load_dword v96, v4, s[12:15], s14 offen
  s_cmp_le_i32 s61, 1
  v_dot2c_f32_bf16_dpp v48, v12, v112 row_newbcast:12 row_mask:0xf bank_mask:0xf
  v_dot2c_f32_bf16_dpp v49, v13, v112 row_newbcast:12 row_mask:0xf bank_mask:0xf
  v_dot2c_f32_bf16_dpp v50, v12, v113 row_newbcast:12 row_mask:0xf bank_mask:0xf
  v_dot2c_f32_bf16_dpp v51, v13, v113 row_newbcast:12 row_mask:0xf bank_mask:0xf
  v_dot2c_f32_bf16_dpp v52, v12, v114 row_newbcast:12 row_mask:0xf bank_mask:0xf
  v_dot2c_f32_bf16_dpp v53, v13, v114 row_newbcast:12 row_mask:0xf bank_mask:0xf
  v_dot2c_f32_bf16_dpp v54, v12, v115 row_newbcast:12 row_mask:0xf bank_mask:0xf
  v_dot2c_f32_bf16_dpp v55, v13, v115 row_newbcast:12 row_mask:0xf bank_mask:0xf
  s_cbranch_scc1 L_vdone
L_dr13:
  s_waitcnt vmcnt(11)
  buffer_load_dword v100, v4, s[12:15], s14 offen
  s_cmp_le_i32 s61, 2
  v_dot2c_f32_bf16_dpp v48, v12, v116 row_newbcast:13 row_mask:0xf bank_mask:0xf
  v_dot2c_f32_bf16_dpp v49, v13, v116 row_newbcast:13 row_mask:0xf bank_mask:0xf
  v_dot2c_f32_bf16_dpp v50, v12, v117 row_newbcast:13 row_mask:0xf bank_mask:0xf
  v_dot2c_f32_bf16_dpp v51, v13, v117 row_newbcast:13 row_mask:0xf bank_mask:0xf
  v_dot2c_f32_bf16_dpp v52, v12, v118 row_newbcast:13 row_mask:0xf bank_mask:0xf
  v_dot2c_f32_bf16_dpp v53, v13, v118 row_newbcast:13 row_mask:0xf bank_mask:0xf
  v_dot2c_f32_bf16_dpp v54, v12, v119 row_newbcast:13 row_mask:0xf bank_mask:0xf
  v_dot2c_f32_bf16_dpp v55, v13, v119 row_newbcast:13 row_mask:0xf bank_mask:0xf
  s_cbranch_scc1 L_vdone
L_dr14:
  s_waitcnt vmcnt(11)
  buffer_load_dword v104, v4, s[12:15], s14 offen
  s_cmp_le_i32 s61, 3
  v_dot2c_f32_bf16_dpp v48, v12, v120 row_newbcast:14 row_mask:0xf bank_mask:0xf
  v_dot2c_f32_bf16_dpp v49, v13, v120 row_newbcast:14 row_mask:0xf bank_mask:0xf
  v_dot2c_f32_bf16_dpp v50, v12, v121 row_newbcast:14 row_mask:0xf bank_mask:0xf
  v_dot2c_f32_bf16_dpp v51, v13, v121 row_newbcast:14 row_mask:0xf bank_mask:0xf
  v_dot2c_f32_bf16_dpp v52, v12, v122 row_newbcast:14 row_mask:0xf bank_mask:0xf
  v_dot2c_f32_bf16_dpp v53, v13, v122 row_newbcast:14 row_mask:0xf bank_mask:0xf
  v_dot2c_f32_bf16_dpp v54, v12, v123 row_newbcast:14 row_mask:0xf bank_mask:0xf
  v_dot2c_f32_bf16_dpp v55, v13, v123 row_newbcast:14 row_mask:0xf bank_mask:0xf
  s_cbranch_scc1 L_vdone
L_dr15:
  s_waitcnt vmcnt(11)
  buffer_load_dword v108, v4, s[12:15], s14 offen
  s_cmp_le_i32 s61, 4
  v_dot2c_f32_bf16_dpp v48, v12, v124 row_newbcast:15 row_mask:0xf bank_mask:0xf
  v_dot2c_f32_bf16_dpp v49, v13, v124 row_newbcast:15 row_mask:0xf bank_mask:0xf
  v_dot2c_f32_bf16_dpp v50, v12, v125 row_newbcast:15 row_mask:0xf bank_mask:0xf
  v_dot2c_f32_bf16_dpp v51, v13, v125 row_newbcast:15 row_mask:0xf bank_mask:0xf
  v_dot2c_f32_bf16_dpp v52, v12, v126 row_newbcast:15 row_mask:0xf bank_mask:0xf
  v_dot2c_f32_bf16_dpp v53, v13, v126 row_newbcast:15 row_mask:0xf bank_mask:0xf
  v_dot2c_f32_bf16_dpp v54, v12, v127 row_newbcast:15 row_mask:0xf bank_mask:0xf
  v_dot2c_f32_bf16_dpp v55, v13, v127 row_newbcast:15 row_mask:0xf bank_mask:0xf
  s_cbranch_scc0 L_drw
L_vdone:
  s_nop 1
  v_permlane32_swap_b32 v48, v50
  v_permlane32_swap_b32 v49, v51
  v_permlane32_swap_b32 v52, v54
  v_permlane32_swap_b32 v53, v55
  v_pk_add_f32 v[48:49], v[48:49], v[50:51]
  v_pk_add_f32 v[52:53], v[52:53], v[54:55]
  s_nop 1
  v_permlane16_swap_b32 v48, v52
  v_permlane16_swap_b32 v49, v53
  v_pk_add_f32 v[48:49], v[48:49], v[52:53]
  ds_write_b64 v17, v[48:49] offset:9216
  ds_add_rtn_u32 v20, v19, v56 offset:11264
  ds_read2st64_b64 v[24:27], v22 offset0:18 offset1:19
  ds_read2st64_b64 v[28:31], v22 offset0:20 offset1:21
  s_waitcnt lgkmcnt(1)
  v_cmpx_eq_u32 vcc, 3, v20
  v_pk_add_f32 v[24:25], v[24:25], v[26:27]
  s_waitcnt lgkmcnt(0)
  v_pk_add_f32 v[28:29], v[28:29], v[30:31]
  v_pk_add_f32 v[24:25], v[24:25], v[28:29]
  v_cvt_pk_bf16_f32 v22, v24, v25
  v_min_u32 v22, -2, v22
  global_store_dword v21, v22, s[40:41] sc1
  s_mov_b64 exec, -1
  s_cmp_lg_u32 s94, 0
  s_cbranch_scc1 L_proj
  s_endpgm
L_helper:
  s_sub_u32 s7, s3, 4
  v_bfe_u32 v3, v0, 4, 2
  v_and_b32 v4, 63, v0
  s_bfe_u32 s4, s59, 0x50001
  s_lshr_b32 s5, s2, 6
  s_mov_b32 s48, 0x05040100
  s_mov_b32 s49, 0x07060302
  v_lshlrev_b32 v6, 4, v4
  v_mov_b32 v10, 0
  v_mov_b32 v62, 0
  v_mov_b32 v15, 0xffffff00
  s_mov_b32 s11, 0x20000
  s_mov_b32 s15, 0x20000
  s_lshr_b32 s62, s2, 1
  s_and_b32 s42, s2, 1
  s_cmp_eq_u32 s42, 0
  s_cselect_b32 s62, s62, 255
  s_cmp_ge_u32 s7, 2
  s_cbranch_scc1 L_pf
  s_cmp_eq_u32 s7, 0
  s_cbranch_scc1 L_front
  s_cmp_lt_u32 s62, 112
  s_cbranch_scc1 L_front
  s_barrier
  s_branch L_nofront
L_front:
  s_setprio 3
  s_and_b32 s42, s59, 1
  s_and_b32 s61, s5, 1
  s_lshl1_add_u32 s61, s42, s61
  s_lshl2_add_u32 s42, s4, s61
  s_lshr_b32 s44, s62, 3
  s_and_b32 s43, s62, 2
  s_lshl2_add_u32 s44, s44, s43
  s_bfe_u32 s43, s62, 0x10002
  s_add_u32 s44, s44, s43
  s_and_b32 s43, s62, 1
  s_lshr_b32 s53, s5, 1
  s_mov_b32 s51, 3584
  s_cmp_eq_u32 s7, 0
  s_cselect_b32 s53, s53, s43
  s_cselect_b32 s60, s42, s44
  s_cselect_b32 s51, 8192, s51
  s_lshl_b32 s10, s51, 9
  s_mul_i32 s52, s51, 121
  s_mul_i32 s50, s53, s51
  s_lshl2_add_u32 s50, s50, s60
  s_lshl_b32 s50, s50, 6
  s_lshl_b32 s42, s51, 3
  v_and_b32 v12, 12, v2
  v_add_u32 v5, v12, v3
  v_mul_u32_u24 v5, s42, v5
  v_and_b32 v12, 3, v2
  v_lshl_add_u32 v5, v12, 4, v5
  v_lshlrev_b32 v12, 10, v3
  v_lshl_add_u32 v12, v2, 4, v12
  s_cmp_eq_u32 s7, 0
  s_waitcnt lgkmcnt(0)
  global_load_dwordx4 v[96:99], v12, s[16:17] offset:0
  global_load_dwordx4 v[100:103], v12, s[16:17] offset:256
  global_load_dwordx4 v[104:107], v12, s[16:17] offset:512
  global_load_dwordx4 v[108:111], v12, s[16:17] offset:768
  s_load_dword s63, s[40:41], 0x90000
  s_cselect_b32 s8, s22, s28
  s_cselect_b32 s9, s23, s29
  buffer_load_dwordx4 v[160:163], v5, s[8:11], s50 offen
  s_add_u32 s50, s50, s51
  buffer_load_dwordx4 v[164:167], v5, s[8:11], s50 offen
  s_add_u32 s50, s50, s51
  buffer_load_dwordx4 v[168:171], v5, s[8:11], s50 offen
  s_add_u32 s50, s50, s51
  buffer_load_dwordx4 v[172:175], v5, s[8:11], s50 offen
  s_add_u32 s50, s50, s51
  buffer_load_dwordx4 v[176:179], v5, s[8:11], s50 offen
  s_add_u32 s50, s50, s51
  buffer_load_dwordx4 v[180:183], v5, s[8:11], s50 offen
  s_add_u32 s50, s50, s51
  buffer_load_dwordx4 v[184:187], v5, s[8:11], s50 offen
  s_add_u32 s50, s50, s51
  buffer_load_dwordx4 v[188:191], v5, s[8:11], s50 offen
  s_add_u32 s50, s50, s52
  buffer_load_dwordx4 v[192:195], v5, s[8:11], s50 offen
  s_add_u32 s50, s50, s51
  buffer_load_dwordx4 v[196:199], v5, s[8:11], s50 offen
  s_add_u32 s50, s50, s51
  buffer_load_dwordx4 v[200:203], v5, s[8:11], s50 offen
  s_add_u32 s50, s50, s51
  buffer_load_dwordx4 v[204:207], v5, s[8:11], s50 offen
  s_add_u32 s50, s50, s51
  buffer_load_dwordx4 v[208:211], v5, s[8:11], s50 offen
  s_add_u32 s50, s50, s51
  buffer_load_dwordx4 v[212:215], v5, s[8:11], s50 offen
  s_add_u32 s50, s50, s51
  buffer_load_dwordx4 v[216:219], v5, s[8:11], s50 offen
  s_add_u32 s50, s50, s51
  buffer_load_dwordx4 v[220:223], v5, s[8:11], s50 offen
  s_barrier
  s_lshl_b32 s42, s7, 12
  v_add_u32 v12, s42, v12
  v_lshrrev_b32 v13, 2, v2
  v_lshlrev_b32 v13, 10, v13
  v_lshl_add_u32 v13, v3, 4, v13
  v_and_b32 v14, 3, v2
  v_lshl_add_u32 v13, v14, 6, v13
  s_lshl_b32 s43, s53, 9
  s_add_u32 s42, s42, s43
  v_add_u32 v13, s42, v13
  s_mov_b32 s54, s7
  s_waitcnt vmcnt(16)
L_ln:
  v_lshlrev_b32 v64, 16, v96
  v_and_b32 v65, 0xffff0000, v96
  v_lshlrev_b32 v66, 16, v97
  v_and_b32 v67, 0xffff0000, v97
  v_lshlrev_b32 v68, 16, v98
  v_and_b32 v69, 0xffff0000, v98
  v_lshlrev_b32 v70, 16, v99
  v_and_b32 v71, 0xffff0000, v99
  v_lshlrev_b32 v72, 16, v100
  v_and_b32 v73, 0xffff0000, v100
  v_lshlrev_b32 v74, 16, v101
  v_and_b32 v75, 0xffff0000, v101
  v_lshlrev_b32 v76, 16, v102
  v_and_b32 v77, 0xffff0000, v102
  v_lshlrev_b32 v78, 16, v103
  v_and_b32 v79, 0xffff0000, v103
  v_lshlrev_b32 v80, 16, v104
  v_and_b32 v81, 0xffff0000, v104
  v_lshlrev_b32 v82, 16, v105
  v_and_b32 v83, 0xffff0000, v105
  v_lshlrev_b32 v84, 16, v106
  v_and_b32 v85, 0xffff0000, v106
  v_lshlrev_b32 v86, 16, v107
  v_and_b32 v87, 0xffff0000, v107
  v_lshlrev_b32 v88, 16, v108
  v_and_b32 v89, 0xffff0000, v108
  v_lshlrev_b32 v90, 16, v109
  v_and_b32 v91, 0xffff0000, v109
  v_lshlrev_b32 v92, 16, v110
  v_and_b32 v93, 0xffff0000, v110
  v_lshlrev_b32 v94, 16, v111
  v_and_b32 v95, 0xffff0000, v111
  v_add_f32 v224, v64, v65
  v_add_f32 v224, v224, v66
  v_add_f32 v224, v224, v67
  v_add_f32 v224, v224, v68
  v_add_f32 v224, v224, v69
  v_add_f32 v224, v224, v70
  v_add_f32 v224, v224, v71
  v_add_f32 v224, v224, v72
  v_add_f32 v224, v224, v73
  v_add_f32 v224, v224, v74
  v_add_f32 v224, v224, v75
  v_add_f32 v224, v224, v76
  v_add_f32 v224, v224, v77
  v_add_f32 v224, v224, v78
  v_add_f32 v224, v224, v79
  v_add_f32 v224, v224, v80
  v_add_f32 v224, v224, v81
  v_add_f32 v224, v224, v82
  v_add_f32 v224, v224, v83
  v_add_f32 v224, v224, v84
  v_add_f32 v224, v224, v85
  v_add_f32 v224, v224, v86
  v_add_f32 v224, v224, v87
  v_add_f32 v224, v224, v88
  v_add_f32 v224, v224, v89
  v_add_f32 v224, v224, v90
  v_add_f32 v224, v224, v91
  v_add_f32 v224, v224, v92
  v_add_f32 v224, v224, v93
  v_add_f32 v224, v224, v94
  v_add_f32 v224, v224, v95
  s_nop 1
  v_add_f32_dpp v224, v224, v224 quad_perm:[1,0,3,2] row_mask:0xf bank_mask:0xf
  s_nop 1
  v_add_f32_dpp v224, v224, v224 quad_perm:[2,3,0,1] row_mask:0xf bank_mask:0xf
  s_nop 1
  v_add_f32_dpp v224, v224, v224 row_half_mirror row_mask:0xf bank_mask:0xf
  s_nop 1
  v_add_f32_dpp v224, v224, v224 row_mirror row_mask:0xf bank_mask:0xf
  v_mul_f32 v224, 0x3b000000, v224
  v_sub_f32 v227, v64, v224
  v_mul_f32 v226, v227, v227
  v_sub_f32 v225, v65, v224
  v_fmac_f32 v226, v225, v225
  v_sub_f32 v227, v66, v224
  v_fmac_f32 v226, v227, v227
  v_sub_f32 v225, v67, v224
  v_fmac_f32 v226, v225, v225
  v_sub_f32 v227, v68, v224
  v_fmac_f32 v226, v227, v227
  v_sub_f32 v225, v69, v224
  v_fmac_f32 v226, v225, v225
  v_sub_f32 v227, v70, v224
  v_fmac_f32 v226, v227, v227
  v_sub_f32 v225, v71, v224
  v_fmac_f32 v226, v225, v225
  v_sub_f32 v227, v72, v224
  v_fmac_f32 v226, v227, v227
  v_sub_f32 v225, v73, v224
  v_fmac_f32 v226, v225, v225
  v_sub_f32 v227, v74, v224
  v_fmac_f32 v226, v227, v227
  v_sub_f32 v225, v75, v224
  v_fmac_f32 v226, v225, v225
  v_sub_f32 v227, v76, v224
  v_fmac_f32 v226, v227, v227
  v_sub_f32 v225, v77, v224
  v_fmac_f32 v226, v225, v225
  v_sub_f32 v227, v78, v224
  v_fmac_f32 v226, v227, v227
  v_sub_f32 v225, v79, v224
  v_fmac_f32 v226, v225, v225
  v_sub_f32 v227, v80, v224
  v_fmac_f32 v226, v227, v227
  v_sub_f32 v225, v81, v224
  v_fmac_f32 v226, v225, v225
  v_sub_f32 v227, v82, v224
  v_fmac_f32 v226, v227, v227
  v_sub_f32 v225, v83, v224
  v_fmac_f32 v226, v225, v225
  v_sub_f32 v227, v84, v224
  v_fmac_f32 v226, v227, v227
  v_sub_f32 v225, v85, v224
  v_fmac_f32 v226, v225, v225
  v_sub_f32 v227, v86, v224
  v_fmac_f32 v226, v227, v227
  v_sub_f32 v225, v87, v224
  v_fmac_f32 v226, v225, v225
  v_sub_f32 v227, v88, v224
  v_fmac_f32 v226, v227, v227
  v_sub_f32 v225, v89, v224
  v_fmac_f32 v226, v225, v225
  v_sub_f32 v227, v90, v224
  v_fmac_f32 v226, v227, v227
  v_sub_f32 v225, v91, v224
  v_fmac_f32 v226, v225, v225
  v_sub_f32 v227, v92, v224
  v_fmac_f32 v226, v227, v227
  v_sub_f32 v225, v93, v224
  v_fmac_f32 v226, v225, v225
  v_sub_f32 v227, v94, v224
  v_fmac_f32 v226, v227, v227
  v_sub_f32 v225, v95, v224
  v_fmac_f32 v226, v225, v225
  s_nop 1
  v_add_f32_dpp v226, v226, v226 quad_perm:[1,0,3,2] row_mask:0xf bank_mask:0xf
  s_nop 1
  v_add_f32_dpp v226, v226, v226 quad_perm:[2,3,0,1] row_mask:0xf bank_mask:0xf
  s_nop 1
  v_add_f32_dpp v226, v226, v226 row_half_mirror row_mask:0xf bank_mask:0xf
  s_nop 1
  v_add_f32_dpp v226, v226, v226 row_mirror row_mask:0xf bank_mask:0xf
  v_mul_f32 v226, 0x3b000000, v226
  v_cvt_pk_bf16_f32 v224, 0, v224
  v_cvt_pk_bf16_f32 v226, 0, v226
  v_add_f32 v226, 0x3727c5ac, v226
  v_cvt_pk_bf16_f32 v226, 0, v226
  v_sqrt_f32 v226, v226
  s_nop 0
  v_cvt_pk_bf16_f32 v226, 0, v226
  v_rcp_f32 v226, v226
  v_sub_f32 v64, v64, v224
  v_sub_f32 v65, v65, v224
  v_sub_f32 v66, v66, v224
  v_sub_f32 v67, v67, v224
  v_sub_f32 v68, v68, v224
  v_sub_f32 v69, v69, v224
  v_sub_f32 v70, v70, v224
  v_sub_f32 v71, v71, v224
  v_sub_f32 v72, v72, v224
  v_sub_f32 v73, v73, v224
  v_sub_f32 v74, v74, v224
  v_sub_f32 v75, v75, v224
  v_sub_f32 v76, v76, v224
  v_sub_f32 v77, v77, v224
  v_sub_f32 v78, v78, v224
  v_sub_f32 v79, v79, v224
  v_sub_f32 v80, v80, v224
  v_sub_f32 v81, v81, v224
  v_sub_f32 v82, v82, v224
  v_sub_f32 v83, v83, v224
  v_sub_f32 v84, v84, v224
  v_sub_f32 v85, v85, v224
  v_sub_f32 v86, v86, v224
  v_sub_f32 v87, v87, v224
  v_sub_f32 v88, v88, v224
  v_sub_f32 v89, v89, v224
  v_sub_f32 v90, v90, v224
  v_sub_f32 v91, v91, v224
  v_sub_f32 v92, v92, v224
  v_sub_f32 v93, v93, v224
  v_sub_f32 v94, v94, v224
  v_sub_f32 v95, v95, v224
  v_cvt_pk_bf16_f32 v64, 0, v64
  v_cvt_pk_bf16_f32 v65, 0, v65
  v_cvt_pk_bf16_f32 v66, 0, v66
  v_cvt_pk_bf16_f32 v67, 0, v67
  v_cvt_pk_bf16_f32 v68, 0, v68
  v_cvt_pk_bf16_f32 v69, 0, v69
  v_cvt_pk_bf16_f32 v70, 0, v70
  v_cvt_pk_bf16_f32 v71, 0, v71
  v_cvt_pk_bf16_f32 v72, 0, v72
  v_cvt_pk_bf16_f32 v73, 0, v73
  v_cvt_pk_bf16_f32 v74, 0, v74
  v_cvt_pk_bf16_f32 v75, 0, v75
  v_cvt_pk_bf16_f32 v76, 0, v76
  v_cvt_pk_bf16_f32 v77, 0, v77
  v_cvt_pk_bf16_f32 v78, 0, v78
  v_cvt_pk_bf16_f32 v79, 0, v79
  v_cvt_pk_bf16_f32 v80, 0, v80
  v_cvt_pk_bf16_f32 v81, 0, v81
  v_cvt_pk_bf16_f32 v82, 0, v82
  v_cvt_pk_bf16_f32 v83, 0, v83
  v_cvt_pk_bf16_f32 v84, 0, v84
  v_cvt_pk_bf16_f32 v85, 0, v85
  v_cvt_pk_bf16_f32 v86, 0, v86
  v_cvt_pk_bf16_f32 v87, 0, v87
  v_cvt_pk_bf16_f32 v88, 0, v88
  v_cvt_pk_bf16_f32 v89, 0, v89
  v_cvt_pk_bf16_f32 v90, 0, v90
  v_cvt_pk_bf16_f32 v91, 0, v91
  v_cvt_pk_bf16_f32 v92, 0, v92
  v_cvt_pk_bf16_f32 v93, 0, v93
  v_cvt_pk_bf16_f32 v94, 0, v94
  v_cvt_pk_bf16_f32 v95, 0, v95
  v_mul_f32 v64, v64, v226
  v_mul_f32 v65, v65, v226
  v_mul_f32 v66, v66, v226
  v_mul_f32 v67, v67, v226
  v_mul_f32 v68, v68, v226
  v_mul_f32 v69, v69, v226
  v_mul_f32 v70, v70, v226
  v_mul_f32 v71, v71, v226
  v_mul_f32 v72, v72, v226
  v_mul_f32 v73, v73, v226
  v_mul_f32 v74, v74, v226
  v_mul_f32 v75, v75, v226
  v_mul_f32 v76, v76, v226
  v_mul_f32 v77, v77, v226
  v_mul_f32 v78, v78, v226
  v_mul_f32 v79, v79, v226
  v_mul_f32 v80, v80, v226
  v_mul_f32 v81, v81, v226
  v_mul_f32 v82, v82, v226
  v_mul_f32 v83, v83, v226
  v_mul_f32 v84, v84, v226
  v_mul_f32 v85, v85, v226
  v_mul_f32 v86, v86, v226
  v_mul_f32 v87, v87, v226
  v_mul_f32 v88, v88, v226
  v_mul_f32 v89, v89, v226
  v_mul_f32 v90, v90, v226
  v_mul_f32 v91, v91, v226
  v_mul_f32 v92, v92, v226
  v_mul_f32 v93, v93, v226
  v_mul_f32 v94, v94, v226
  v_mul_f32 v95, v95, v226
  v_cvt_pk_bf16_f32 v96, v64, v65
  v_cvt_pk_bf16_f32 v97, v66, v67
  v_cvt_pk_bf16_f32 v98, v68, v69
  v_cvt_pk_bf16_f32 v99, v70, v71
  v_cvt_pk_bf16_f32 v100, v72, v73
  v_cvt_pk_bf16_f32 v101, v74, v75
  v_cvt_pk_bf16_f32 v102, v76, v77
  v_cvt_pk_bf16_f32 v103, v78, v79
  v_cvt_pk_bf16_f32 v104, v80, v81
  v_cvt_pk_bf16_f32 v105, v82, v83
  v_cvt_pk_bf16_f32 v106, v84, v85
  v_cvt_pk_bf16_f32 v107, v86, v87
  v_cvt_pk_bf16_f32 v108, v88, v89
  v_cvt_pk_bf16_f32 v109, v90, v91
  v_cvt_pk_bf16_f32 v110, v92, v93
  v_cvt_pk_bf16_f32 v111, v94, v95
  s_sub_u32 s54, s54, 1
  s_cbranch_scc0 L_ln
  ds_write_b128 v12, v[96:99] offset:0
  ds_write_b128 v12, v[100:103] offset:256
  ds_write_b128 v12, v[104:107] offset:512
  ds_write_b128 v12, v[108:111] offset:768
  s_waitcnt vmcnt(8)
  v_perm_b32 v128, v164, v160, s48
  v_perm_b32 v129, v172, v168, s48
  v_perm_b32 v130, v180, v176, s48
  v_perm_b32 v131, v188, v184, s48
  v_perm_b32 v132, v164, v160, s49
  v_perm_b32 v133, v172, v168, s49
  v_perm_b32 v134, v180, v176, s49
  v_perm_b32 v135, v188, v184, s49
  v_perm_b32 v136, v165, v161, s48
  v_perm_b32 v137, v173, v169, s48
  v_perm_b32 v138, v181, v177, s48
  v_perm_b32 v139, v189, v185, s48
  v_perm_b32 v140, v165, v161, s49
  v_perm_b32 v141, v173, v169, s49
  v_perm_b32 v142, v181, v177, s49
  v_perm_b32 v143, v189, v185, s49
  v_perm_b32 v144, v166, v162, s48
  v_perm_b32 v145, v174, v170, s48
  v_perm_b32 v146, v182, v178, s48
  v_perm_b32 v147, v190, v186, s48
  v_perm_b32 v148, v166, v162, s49
  v_perm_b32 v149, v174, v170, s49
  v_perm_b32 v150, v182, v178, s49
  v_perm_b32 v151, v190, v186, s49
  v_perm_b32 v152, v167, v163, s48
  v_perm_b32 v153, v175, v171, s48
  v_perm_b32 v154, v183, v179, s48
  v_perm_b32 v155, v191, v187, s48
  v_perm_b32 v156, v167, v163, s49
  v_perm_b32 v157, v175, v171, s49
  v_perm_b32 v158, v183, v179, s49
  v_perm_b32 v159, v191, v187, s49
  s_waitcnt lgkmcnt(0)
  ds_read_b128 v[16:19], v13 offset:0
  ds_read_b128 v[20:23], v13 offset:256
  s_add_u32 s63, s63, 0x61c88647
  s_bfe_u32 s96, s63, 0x80000
  s_bfe_u32 s97, s63, 0x80008
  s_bfe_u32 s98, s63, 0x80010
  s_bfe_u32 s99, s63, 0x80018
  s_waitcnt vmcnt(0)
  v_perm_b32 v160, v196, v192, s48
  v_perm_b32 v161, v204, v200, s48
  v_perm_b32 v162, v212, v208, s48
  v_perm_b32 v163, v220, v216, s48
  v_perm_b32 v164, v196, v192, s49
  v_perm_b32 v165, v204, v200, s49
  v_perm_b32 v166, v212, v208, s49
  v_perm_b32 v167, v220, v216, s49
  v_perm_b32 v168, v197, v193, s48
  v_perm_b32 v169, v205, v201, s48
  v_perm_b32 v170, v213, v209, s48
  v_perm_b32 v171, v221, v217, s48
  v_perm_b32 v172, v197, v193, s49
  v_perm_b32 v173, v205, v201, s49
  v_perm_b32 v174, v213, v209, s49
  v_perm_b32 v175, v221, v217, s49
  v_perm_b32 v176, v198, v194, s48
  v_perm_b32 v177, v206, v202, s48
  v_perm_b32 v178, v214, v210, s48
  v_perm_b32 v179, v222, v218, s48
  v_perm_b32 v180, v198, v194, s49
  v_perm_b32 v181, v206, v202, s49
  v_perm_b32 v182, v214, v210, s49
  v_perm_b32 v183, v222, v218, s49
  v_perm_b32 v184, v199, v195, s48
  v_perm_b32 v185, v207, v203, s48
  v_perm_b32 v186, v215, v211, s48
  v_perm_b32 v187, v223, v219, s48
  v_perm_b32 v188, v199, v195, s49
  v_perm_b32 v189, v207, v203, s49
  v_perm_b32 v190, v215, v211, s49
  v_perm_b32 v191, v223, v219, s49
  s_waitcnt lgkmcnt(0)
  v_mfma_f32_16x16x32_bf16 v[32:35], v[16:19], v[128:131], 0
  v_mfma_f32_16x16x32_bf16 v[36:39], v[16:19], v[132:135], 0
  v_mfma_f32_16x16x32_bf16 v[40:43], v[16:19], v[136:139], 0
  v_mfma_f32_16x16x32_bf16 v[44:47], v[16:19], v[140:143], 0
  v_mfma_f32_16x16x32_bf16 v[48:51], v[16:19], v[144:147], 0
  v_mfma_f32_16x16x32_bf16 v[52:55], v[16:19], v[148:151], 0
  v_mfma_f32_16x16x32_bf16 v[56:59], v[16:19], v[152:155], 0
  v_mfma_f32_16x16x32_bf16 v[60:63], v[16:19], v[156:159], 0
  v_mfma_f32_16x16x32_bf16 v[32:35], v[20:23], v[160:163], v[32:35]
  v_mfma_f32_16x16x32_bf16 v[36:39], v[20:23], v[164:167], v[36:39]
  v_mfma_f32_16x16x32_bf16 v[40:43], v[20:23], v[168:171], v[40:43]
  v_mfma_f32_16x16x32_bf16 v[44:47], v[20:23], v[172:175], v[44:47]
  v_mfma_f32_16x16x32_bf16 v[48:51], v[20:23], v[176:179], v[48:51]
  v_mfma_f32_16x16x32_bf16 v[52:55], v[20:23], v[180:183], v[52:55]
  v_mfma_f32_16x16x32_bf16 v[56:59], v[20:23], v[184:187], v[56:59]
  v_mfma_f32_16x16x32_bf16 v[60:63], v[20:23], v[188:191], v[60:63]
  s_cmp_eq_u32 s7, 0
  s_cbranch_scc1 L_qaddr
  s_lshl1_add_u32 s42, s60, s53
  s_lshl_b32 s42, s42, 9
  s_add_u32 s42, s42, 0x180000
  v_lshrrev_b32 v12, 3, v2
  v_lshlrev_b32 v12, 8, v12
  v_lshl_add_u32 v12, v3, 6, v12
  v_and_b32 v13, 3, v2
  v_lshl_add_u32 v12, v13, 4, v12
  s_branch L_fst
L_qaddr:
  s_lshl_b32 s42, s4, 12
  s_lshl_b32 s43, s53, 9
  s_add_u32 s42, s42, s43
  s_lshl_b32 s43, s61, 7
  s_add_u32 s42, s42, s43
  s_add_u32 s42, s42, 0x100000
  v_lshlrev_b32 v12, 10, v3
  v_and_b32 v13, 3, v2
  v_lshl_add_u32 v12, v13, 5, v12
  v_lshrrev_b32 v13, 3, v2
  v_lshl_add_u32 v12, v13, 4, v12
L_fst:
  v_add_u32 v12, s42, v12
  v_add_f32_dpp v224, v34, v32 row_ror:8 row_mask:0xf bank_mask:0x1
  v_add_f32_dpp v225, v38, v36 row_ror:8 row_mask:0xf bank_mask:0x1
  v_add_f32_dpp v226, v42, v40 row_ror:8 row_mask:0xf bank_mask:0x1
  v_add_f32_dpp v227, v46, v44 row_ror:8 row_mask:0xf bank_mask:0x1
  v_add_f32_dpp v224, v35, v33 row_ror:8 row_mask:0xf bank_mask:0x2
  v_add_f32_dpp v225, v39, v37 row_ror:8 row_mask:0xf bank_mask:0x2
  v_add_f32_dpp v226, v43, v41 row_ror:8 row_mask:0xf bank_mask:0x2
  v_add_f32_dpp v227, v47, v45 row_ror:8 row_mask:0xf bank_mask:0x2
  v_add_f32_dpp v224, v48, v50 row_ror:8 row_mask:0xf bank_mask:0x4
  v_add_f32_dpp v225, v52, v54 row_ror:8 row_mask:0xf bank_mask:0x4
  v_add_f32_dpp v226, v56, v58 row_ror:8 row_mask:0xf bank_mask:0x4
  v_add_f32_dpp v227, v60, v62 row_ror:8 row_mask:0xf bank_mask:0x4
  v_add_f32_dpp v224, v49, v51 row_ror:8 row_mask:0xf bank_mask:0x8
  v_add_f32_dpp v225, v53, v55 row_ror:8 row_mask:0xf bank_mask:0x8
  v_add_f32_dpp v226, v57, v59 row_ror:8 row_mask:0xf bank_mask:0x8
  v_add_f32_dpp v227, v61, v63 row_ror:8 row_mask:0xf bank_mask:0x8
  v_add_f32_dpp v224, v224, v224 row_shl:4 row_mask:0xf bank_mask:0x5
  v_add_f32_dpp v225, v225, v225 row_shl:4 row_mask:0xf bank_mask:0x5
  v_add_f32_dpp v226, v226, v226 row_shl:4 row_mask:0xf bank_mask:0x5
  v_add_f32_dpp v227, v227, v227 row_shl:4 row_mask:0xf bank_mask:0x5
  s_mov_b32 exec_lo, 0x0f0f0f0f
  s_mov_b32 exec_hi, 0x0f0f0f0f
  v_and_or_b32 v224, v224, v15, s96
  v_and_or_b32 v225, v225, v15, s97
  v_and_or_b32 v226, v226, v15, s98
  v_and_or_b32 v227, v227, v15, s99
  global_store_dwordx4 v12, v[224:227], s[40:41] sc1
  s_mov_b64 exec, -1
  s_cmp_lg_u32 s7, 0
  s_cbranch_scc1 L_fdone
  s_lshl_b32 s42, s4, 12
  s_lshl_b32 s43, s5, 10
  s_add_u32 s42, s42, s43
  s_add_u32 s42, s42, 0x100000
  v_add_u32 v12, s42, v6
  v_lshlrev_b32 v8, 2, v4
  v_mov_b32 v9, -1
  ds_write_b32 v8, v9 offset:8448
  v_mov_b32 v9, s63
  ds_write_b32 v10, v9 offset:8704
  ds_write_b32 v8, v10 offset:11776
  ds_write2st64_b32 v8, v10, v10 offset0:44 offset1:45
  s_and_b32 s42, s2, 0x81
  s_cmp_eq_u32 s42, 0x81
  s_cselect_b32 s94, 1, 0
  s_cselect_b32 s42, 32, 23
  v_mov_b32 v9, s42
  ds_write_b32 v10, v9 offset:8720
  v_and_b32 v9, 31, v4
  v_lshlrev_b32 v9, 3, v9
  s_waitcnt vmcnt(0)
  s_mov_b32 s55, 262144
L_sp_q:
  global_load_dwordx4 v[32:35], v12, s[40:41] offset:0 sc1
  s_waitcnt vmcnt(0)
  v_xor_b32 v32, s96, v32
  v_xor_b32 v33, s97, v33
  v_xor_b32 v34, s98, v34
  v_xor_b32 v35, s99, v35
  v_or3_b32 v13, v32, v33, v34
  v_or_b32 v13, v13, v35
  v_cmp_ne_u32_sdwa vcc, v13, v10 src0_sel:BYTE_0 src1_sel:DWORD
  s_cbranch_vccz L_sp_q_done
  s_sleep 1
  s_sub_u32 s55, s55, 1
  s_cmp_lg_u32 s55, 0
  s_cbranch_scc1 L_sp_q
L_sp_q_done:
  v_mov_b32 v36, v32
  v_mov_b32 v37, v33
  v_mov_b32 v38, v34
  v_mov_b32 v39, v35
  s_nop 1
  v_permlane32_swap_b32 v32, v36
  v_permlane32_swap_b32 v33, v37
  v_permlane32_swap_b32 v34, v38
  v_permlane32_swap_b32 v35, v39
  v_add_f32 v32, v32, v36
  v_add_f32 v33, v33, v37
  v_add_f32 v34, v34, v38
  v_add_f32 v35, v35, v39
  v_cvt_pk_bf16_f32 v32, v32, v33
  v_cvt_pk_bf16_f32 v33, v34, v35
  ds_write_b64 v9, v[32:33] offset:8192
L_fdone:
  s_setprio 0
  s_waitcnt lgkmcnt(0)
  s_branch L_b1
L_nofront:
  s_waitcnt lgkmcnt(0)
  s_cmp_lg_u32 s7, 2
  s_cbranch_scc1 L_noclr
  s_lshl_b32 s42, s59, 8
  s_add_u32 s42, s42, 0x40000
  v_lshl_add_u32 v12, v4, 2, s42
  v_mov_b32 v13, -1
  global_store_dword v12, v13, s[40:41] sc1
L_noclr:
L_b1:
  s_and_b32 s42, s2, 0x81
  s_cmp_eq_u32 s42, 0x81
  s_cselect_b32 s94, 1, 0
  s_barrier
  ds_read_b32 v13, v10 offset:8704
  s_waitcnt lgkmcnt(0)
  v_readfirstlane_b32 s63, v13
  s_bfe_u32 s96, s63, 0x80000
  s_bfe_u32 s97, s63, 0x80008
  s_bfe_u32 s98, s63, 0x80010
  s_bfe_u32 s99, s63, 0x80018
  s_cmp_lg_u32 s7, 1
  s_cbranch_scc1 L_not1
  s_cmp_ge_u32 s62, 112
  s_cbranch_scc1 L_not1
  s_lshr_b32 s60, s62, 4
  s_and_b32 s61, s62, 3
  s_and_b32 s43, s62, 8
  s_lshl1_add_u32 s61, s61, s43
  s_bfe_u32 s43, s62, 0x10002
  s_add_u32 s61, s61, s43
  s_lshl_b32 s50, s60, 18
  s_lshl_b32 s43, s61, 6
  s_add_u32 s50, s50, s43
  v_and_b32 v12, 12, v2
  v_add_u32 v14, v12, v3
  v_lshlrev_b32 v14, 13, v14
  v_and_b32 v12, 3, v2
  v_lshl_add_u32 v14, v12, 4, v14
  s_mov_b32 s12, s32
  s_mov_b32 s13, s33
  s_mov_b32 s14, 1835008
  buffer_load_dwordx4 v[192:195], v14, s[12:15], s50 offen
  s_add_u32 s50, s50, 1024
  buffer_load_dwordx4 v[196:199], v14, s[12:15], s50 offen
  s_add_u32 s50, s50, 1024
  buffer_load_dwordx4 v[200:203], v14, s[12:15], s50 offen
  s_add_u32 s50, s50, 1024
  buffer_load_dwordx4 v[204:207], v14, s[12:15], s50 offen
  s_add_u32 s50, s50, 1024
  s_waitcnt vmcnt(3)
  buffer_load_dwordx4 v[208:211], v14, s[12:15], s50 offen
  s_add_u32 s50, s50, 1024
  s_waitcnt vmcnt(3)
  buffer_load_dwordx4 v[212:215], v14, s[12:15], s50 offen
  s_add_u32 s50, s50, 1024
  s_waitcnt vmcnt(3)
  buffer_load_dwordx4 v[216:219], v14, s[12:15], s50 offen
  s_add_u32 s50, s50, 1024
  s_waitcnt vmcnt(3)
  buffer_load_dwordx4 v[220:223], v14, s[12:15], s50 offen
  s_add_u32 s50, s50, 123904
  s_waitcnt vmcnt(3)
  buffer_load_dwordx4 v[32:35], v14, s[12:15], s50 offen
  s_add_u32 s50, s50, 1024
  s_waitcnt vmcnt(3)
  buffer_load_dwordx4 v[36:39], v14, s[12:15], s50 offen
  s_add_u32 s50, s50, 1024
  s_waitcnt vmcnt(3)
  buffer_load_dwordx4 v[40:43], v14, s[12:15], s50 offen
  s_add_u32 s50, s50, 1024
  s_waitcnt vmcnt(3)
  buffer_load_dwordx4 v[44:47], v14, s[12:15], s50 offen
  s_add_u32 s50, s50, 1024
  s_waitcnt vmcnt(3)
  buffer_load_dwordx4 v[48:51], v14, s[12:15], s50 offen
  s_add_u32 s50, s50, 1024
  s_waitcnt vmcnt(3)
  buffer_load_dwordx4 v[52:55], v14, s[12:15], s50 offen
  s_add_u32 s50, s50, 1024
  s_waitcnt vmcnt(3)
  buffer_load_dwordx4 v[56:59], v14, s[12:15], s50 offen
  s_add_u32 s50, s50, 1024
  s_waitcnt vmcnt(3)
  buffer_load_dwordx4 v[60:63], v14, s[12:15], s50 offen
  s_lshl_b32 s43, s60, 9
  v_lshlrev_b32 v13, 4, v3
  v_and_b32 v12, 3, v2
  v_lshl_add_u32 v13, v12, 6, v13
  v_add_u32 v13, s43, v13
  global_load_dwordx4 v[240:243], v13, s[30:31]
  global_load_dwordx4 v[244:247], v13, s[30:31] offset:256
  v_and_b32 v12, 3, v2
  v_lshlrev_b32 v12, 10, v12
  v_lshrrev_b32 v13, 2, v2
  v_lshl_add_u32 v12, v13, 6, v12
  v_lshl_add_u32 v12, v3, 4, v12
  s_lshl_b32 s42, s60, 13
  s_add_u32 s42, s42, 0x180000
  v_add_u32 v224, s42, v12
  v_add_u32 v225, 0x1000, v224
  s_mov_b32 s55, 262144
L_sp_u:
  global_load_dwordx4 v[128:131], v224, s[40:41] offset:0 sc1
  global_load_dwordx4 v[132:135], v224, s[40:41] offset:256 sc1
  global_load_dwordx4 v[136:139], v225, s[40:41] offset:0 sc1
  global_load_dwordx4 v[140:143], v225, s[40:41] offset:256 sc1
  global_load_dwordx4 v[144:147], v224, s[40:41] offset:512 sc1
  global_load_dwordx4 v[148:151], v224, s[40:41] offset:768 sc1
  global_load_dwordx4 v[152:155], v225, s[40:41] offset:512 sc1
  global_load_dwordx4 v[156:159], v225, s[40:41] offset:768 sc1
  s_waitcnt vmcnt(0)
  v_xor_b32 v128, s96, v128
  v_xor_b32 v129, s97, v129
  v_xor_b32 v130, s98, v130
  v_xor_b32 v131, s99, v131
  v_xor_b32 v132, s96, v132
  v_xor_b32 v133, s97, v133
  v_xor_b32 v134, s98, v134
  v_xor_b32 v135, s99, v135
  v_xor_b32 v136, s96, v136
  v_xor_b32 v137, s97, v137
  v_xor_b32 v138, s98, v138
  v_xor_b32 v139, s99, v139
  v_xor_b32 v140, s96, v140
  v_xor_b32 v141, s97, v141
  v_xor_b32 v142, s98, v142
  v_xor_b32 v143, s99, v143
  v_xor_b32 v144, s96, v144
  v_xor_b32 v145, s97, v145
  v_xor_b32 v146, s98, v146
  v_xor_b32 v147, s99, v147
  v_xor_b32 v148, s96, v148
  v_xor_b32 v149, s97, v149
  v_xor_b32 v150, s98, v150
  v_xor_b32 v151, s99, v151
  v_xor_b32 v152, s96, v152
  v_xor_b32 v153, s97, v153
  v_xor_b32 v154, s98, v154
  v_xor_b32 v155, s99, v155
  v_xor_b32 v156, s96, v156
  v_xor_b32 v157, s97, v157
  v_xor_b32 v158, s98, v158
  v_xor_b32 v159, s99, v159
  v_or3_b32 v13, v128, v129, v130
  v_or3_b32 v13, v13, v131, v132
  v_or3_b32 v13, v13, v133, v134
  v_or3_b32 v13, v13, v135, v136
  v_or3_b32 v13, v13, v137, v138
  v_or3_b32 v13, v13, v139, v140
  v_or3_b32 v13, v13, v141, v142
  v_or3_b32 v13, v13, v143, v144
  v_or3_b32 v13, v13, v145, v146
  v_or3_b32 v13, v13, v147, v148
  v_or3_b32 v13, v13, v149, v150
  v_or3_b32 v13, v13, v151, v152
  v_or3_b32 v13, v13, v153, v154
  v_or3_b32 v13, v13, v155, v156
  v_or3_b32 v13, v13, v157, v158
  v_or_b32 v13, v13, v159
  v_cmp_ne_u32_sdwa vcc, v13, v10 src0_sel:BYTE_0 src1_sel:DWORD
  s_cbranch_vccz L_sp_u_done
  s_sleep 32
  s_sub_u32 s55, s55, 1
  s_cmp_lg_u32 s55, 0
  s_cbranch_scc1 L_sp_u
L_sp_u_done:
  v_lshlrev_b32 v176, 16, v240
  v_and_b32 v177, 0xffff0000, v240
  v_lshlrev_b32 v178, 16, v241
  v_and_b32 v179, 0xffff0000, v241
  v_lshlrev_b32 v180, 16, v242
  v_and_b32 v181, 0xffff0000, v242
  v_lshlrev_b32 v182, 16, v243
  v_and_b32 v183, 0xffff0000, v243
  v_lshlrev_b32 v184, 16, v244
  v_and_b32 v185, 0xffff0000, v244
  v_lshlrev_b32 v186, 16, v245
  v_and_b32 v187, 0xffff0000, v245
  v_lshlrev_b32 v188, 16, v246
  v_and_b32 v189, 0xffff0000, v246
  v_lshlrev_b32 v190, 16, v247
  v_and_b32 v191, 0xffff0000, v247
  v_add_f32 v128, v128, v144
  v_add_f32 v129, v129, v145
  v_add_f32 v130, v130, v146
  v_add_f32 v131, v131, v147
  v_add_f32 v132, v132, v148
  v_add_f32 v133, v133, v149
  v_add_f32 v134, v134, v150
  v_add_f32 v135, v135, v151
  v_add_f32 v136, v136, v152
  v_add_f32 v137, v137, v153
  v_add_f32 v138, v138, v154
  v_add_f32 v139, v139, v155
  v_add_f32 v140, v140, v156
  v_add_f32 v141, v141, v157
  v_add_f32 v142, v142, v158
  v_add_f32 v143, v143, v159
  v_cvt_pk_bf16_f32 v128, 0, v128
  v_cvt_pk_bf16_f32 v129, 0, v129
  v_cvt_pk_bf16_f32 v130, 0, v130
  v_cvt_pk_bf16_f32 v131, 0, v131
  v_cvt_pk_bf16_f32 v132, 0, v132
  v_cvt_pk_bf16_f32 v133, 0, v133
  v_cvt_pk_bf16_f32 v134, 0, v134
  v_cvt_pk_bf16_f32 v135, 0, v135
  v_cvt_pk_bf16_f32 v136, 0, v136
  v_cvt_pk_bf16_f32 v137, 0, v137
  v_cvt_pk_bf16_f32 v138, 0, v138
  v_cvt_pk_bf16_f32 v139, 0, v139
  v_cvt_pk_bf16_f32 v140, 0, v140
  v_cvt_pk_bf16_f32 v141, 0, v141
  v_cvt_pk_bf16_f32 v142, 0, v142
  v_cvt_pk_bf16_f32 v143, 0, v143
  v_add_f32 v128, v128, v176
  v_add_f32 v129, v129, v177
  v_add_f32 v130, v130, v178
  v_add_f32 v131, v131, v179
  v_add_f32 v132, v132, v180
  v_add_f32 v133, v133, v181
  v_add_f32 v134, v134, v182
  v_add_f32 v135, v135, v183
  v_add_f32 v136, v136, v184
  v_add_f32 v137, v137, v185
  v_add_f32 v138, v138, v186
  v_add_f32 v139, v139, v187
  v_add_f32 v140, v140, v188
  v_add_f32 v141, v141, v189
  v_add_f32 v142, v142, v190
  v_add_f32 v143, v143, v191
  v_cvt_pk_bf16_f32 v128, 0, v128
  v_cvt_pk_bf16_f32 v129, 0, v129
  v_cvt_pk_bf16_f32 v130, 0, v130
  v_cvt_pk_bf16_f32 v131, 0, v131
  v_cvt_pk_bf16_f32 v132, 0, v132
  v_cvt_pk_bf16_f32 v133, 0, v133
  v_cvt_pk_bf16_f32 v134, 0, v134
  v_cvt_pk_bf16_f32 v135, 0, v135
  v_cvt_pk_bf16_f32 v136, 0, v136
  v_cvt_pk_bf16_f32 v137, 0, v137
  v_cvt_pk_bf16_f32 v138, 0, v138
  v_cvt_pk_bf16_f32 v139, 0, v139
  v_cvt_pk_bf16_f32 v140, 0, v140
  v_cvt_pk_bf16_f32 v141, 0, v141
  v_cvt_pk_bf16_f32 v142, 0, v142
  v_cvt_pk_bf16_f32 v143, 0, v143
  s_mov_b32 s42, 0xbdd2d3e8
  s_mov_b32 s43, 0xc0135761
  v_mov_b32 v12, s43
  v_mul_f32 v144, v128, v128
  v_mul_f32 v145, v129, v129
  v_mul_f32 v146, v130, v130
  v_mul_f32 v147, v131, v131
  v_mul_f32 v148, v132, v132
  v_mul_f32 v149, v133, v133
  v_mul_f32 v150, v134, v134
  v_mul_f32 v151, v135, v135
  v_mul_f32 v152, v136, v136
  v_mul_f32 v153, v137, v137
  v_mul_f32 v154, v138, v138
  v_mul_f32 v155, v139, v139
  v_mul_f32 v156, v140, v140
  v_mul_f32 v157, v141, v141
  v_mul_f32 v158, v142, v142
  v_mul_f32 v159, v143, v143
  v_fma_f32 v144, v144, s42, v12
  v_fma_f32 v145, v145, s42, v12
  v_fma_f32 v146, v146, s42, v12
  v_fma_f32 v147, v147, s42, v12
  v_fma_f32 v148, v148, s42, v12
  v_fma_f32 v149, v149, s42, v12
  v_fma_f32 v150, v150, s42, v12
  v_fma_f32 v151, v151, s42, v12
  v_fma_f32 v152, v152, s42, v12
  v_fma_f32 v153, v153, s42, v12
  v_fma_f32 v154, v154, s42, v12
  v_fma_f32 v155, v155, s42, v12
  v_fma_f32 v156, v156, s42, v12
  v_fma_f32 v157, v157, s42, v12
  v_fma_f32 v158, v158, s42, v12
  v_fma_f32 v159, v159, s42, v12
  v_mul_f32 v144, v144, v128
  v_mul_f32 v145, v145, v129
  v_mul_f32 v146, v146, v130
  v_mul_f32 v147, v147, v131
  v_mul_f32 v148, v148, v132
  v_mul_f32 v149, v149, v133
  v_mul_f32 v150, v150, v134
  v_mul_f32 v151, v151, v135
  v_mul_f32 v152, v152, v136
  v_mul_f32 v153, v153, v137
  v_mul_f32 v154, v154, v138
  v_mul_f32 v155, v155, v139
  v_mul_f32 v156, v156, v140
  v_mul_f32 v157, v157, v141
  v_mul_f32 v158, v158, v142
  v_mul_f32 v159, v159, v143
  v_exp_f32 v144, v144
  v_exp_f32 v145, v145
  v_exp_f32 v146, v146
  v_exp_f32 v147, v147
  v_exp_f32 v148, v148
  v_exp_f32 v149, v149
  v_exp_f32 v150, v150
  v_exp_f32 v151, v151
  v_exp_f32 v152, v152
  v_exp_f32 v153, v153
  v_exp_f32 v154, v154
  v_exp_f32 v155, v155
  v_exp_f32 v156, v156
  v_exp_f32 v157, v157
  v_exp_f32 v158, v158
  v_exp_f32 v159, v159
  v_add_f32 v144, 1.0, v144
  v_add_f32 v145, 1.0, v145
  v_add_f32 v146, 1.0, v146
  v_add_f32 v147, 1.0, v147
  v_add_f32 v148, 1.0, v148
  v_add_f32 v149, 1.0, v149
  v_add_f32 v150, 1.0, v150
  v_add_f32 v151, 1.0, v151
  v_add_f32 v152, 1.0, v152
  v_add_f32 v153, 1.0, v153
  v_add_f32 v154, 1.0, v154
  v_add_f32 v155, 1.0, v155
  v_add_f32 v156, 1.0, v156
  v_add_f32 v157, 1.0, v157
  v_add_f32 v158, 1.0, v158
  v_add_f32 v159, 1.0, v159
  v_rcp_f32 v144, v144
  v_rcp_f32 v145, v145
  v_rcp_f32 v146, v146
  v_rcp_f32 v147, v147
  v_rcp_f32 v148, v148
  v_rcp_f32 v149, v149
  v_rcp_f32 v150, v150
  v_rcp_f32 v151, v151
  v_rcp_f32 v152, v152
  v_rcp_f32 v153, v153
  v_rcp_f32 v154, v154
  v_rcp_f32 v155, v155
  v_rcp_f32 v156, v156
  v_rcp_f32 v157, v157
  v_rcp_f32 v158, v158
  v_rcp_f32 v159, v159
  v_mul_f32 v128, v128, v144
  v_mul_f32 v129, v129, v145
  v_mul_f32 v130, v130, v146
  v_mul_f32 v131, v131, v147
  v_mul_f32 v132, v132, v148
  v_mul_f32 v133, v133, v149
  v_mul_f32 v134, v134, v150
  v_mul_f32 v135, v135, v151
  v_mul_f32 v136, v136, v152
  v_mul_f32 v137, v137, v153
  v_mul_f32 v138, v138, v154
  v_mul_f32 v139, v139, v155
  v_mul_f32 v140, v140, v156
  v_mul_f32 v141, v141, v157
  v_mul_f32 v142, v142, v158
  v_mul_f32 v143, v143, v159
  v_cvt_pk_bf16_f32 v16, v128, v129
  v_cvt_pk_bf16_f32 v17, v130, v131
  v_cvt_pk_bf16_f32 v18, v132, v133
  v_cvt_pk_bf16_f32 v19, v134, v135
  v_cvt_pk_bf16_f32 v20, v136, v137
  v_cvt_pk_bf16_f32 v21, v138, v139
  v_cvt_pk_bf16_f32 v22, v140, v141
  v_cvt_pk_bf16_f32 v23, v142, v143
  v_perm_b32 v128, v196, v192, s48
  v_perm_b32 v129, v204, v200, s48
  v_perm_b32 v130, v212, v208, s48
  v_perm_b32 v131, v220, v216, s48
  v_perm_b32 v132, v196, v192, s49
  v_perm_b32 v133, v204, v200, s49
  v_perm_b32 v134, v212, v208, s49
  v_perm_b32 v135, v220, v216, s49
  v_perm_b32 v136, v197, v193, s48
  v_perm_b32 v137, v205, v201, s48
  v_perm_b32 v138, v213, v209, s48
  v_perm_b32 v139, v221, v217, s48
  v_perm_b32 v140, v197, v193, s49
  v_perm_b32 v141, v205, v201, s49
  v_perm_b32 v142, v213, v209, s49
  v_perm_b32 v143, v221, v217, s49
  v_perm_b32 v144, v198, v194, s48
  v_perm_b32 v145, v206, v202, s48
  v_perm_b32 v146, v214, v210, s48
  v_perm_b32 v147, v222, v218, s48
  v_perm_b32 v148, v198, v194, s49
  v_perm_b32 v149, v206, v202, s49
  v_perm_b32 v150, v214, v210, s49
  v_perm_b32 v151, v222, v218, s49
  v_perm_b32 v152, v199, v195, s48
  v_perm_b32 v153, v207, v203, s48
  v_perm_b32 v154, v215, v211, s48
  v_perm_b32 v155, v223, v219, s48
  v_perm_b32 v156, v199, v195, s49
  v_perm_b32 v157, v207, v203, s49
  v_perm_b32 v158, v215, v211, s49
  v_perm_b32 v159, v223, v219, s49
  v_perm_b32 v160, v36, v32, s48
  v_perm_b32 v161, v44, v40, s48
  v_perm_b32 v162, v52, v48, s48
  v_perm_b32 v163, v60, v56, s48
  v_perm_b32 v164, v36, v32, s49
  v_perm_b32 v165, v44, v40, s49
  v_perm_b32 v166, v52, v48, s49
  v_perm_b32 v167, v60, v56, s49
  v_perm_b32 v168, v37, v33, s48
  v_perm_b32 v169, v45, v41, s48
  v_perm_b32 v170, v53, v49, s48
  v_perm_b32 v171, v61, v57, s48
  v_perm_b32 v172, v37, v33, s49
  v_perm_b32 v173, v45, v41, s49
  v_perm_b32 v174, v53, v49, s49
  v_perm_b32 v175, v61, v57, s49
  v_perm_b32 v176, v38, v34, s48
  v_perm_b32 v177, v46, v42, s48
  v_perm_b32 v178, v54, v50, s48
  v_perm_b32 v179, v62, v58, s48
  v_perm_b32 v180, v38, v34, s49
  v_perm_b32 v181, v46, v42, s49
  v_perm_b32 v182, v54, v50, s49
  v_perm_b32 v183, v62, v58, s49
  v_perm_b32 v184, v39, v35, s48
  v_perm_b32 v185, v47, v43, s48
  v_perm_b32 v186, v55, v51, s48
  v_perm_b32 v187, v63, v59, s48
  v_perm_b32 v188, v39, v35, s49
  v_perm_b32 v189, v47, v43, s49
  v_perm_b32 v190, v55, v51, s49
  v_perm_b32 v191, v63, v59, s49
  v_mfma_f32_16x16x32_bf16 v[32:35], v[16:19], v[128:131], 0
  v_mfma_f32_16x16x32_bf16 v[36:39], v[16:19], v[132:135], 0
  v_mfma_f32_16x16x32_bf16 v[40:43], v[16:19], v[136:139], 0
  v_mfma_f32_16x16x32_bf16 v[44:47], v[16:19], v[140:143], 0
  v_mfma_f32_16x16x32_bf16 v[48:51], v[16:19], v[144:147], 0
  v_mfma_f32_16x16x32_bf16 v[52:55], v[16:19], v[148:151], 0
  v_mfma_f32_16x16x32_bf16 v[56:59], v[16:19], v[152:155], 0
  v_mfma_f32_16x16x32_bf16 v[60:63], v[16:19], v[156:159], 0
  v_mfma_f32_16x16x32_bf16 v[32:35], v[20:23], v[160:163], v[32:35]
  v_mfma_f32_16x16x32_bf16 v[36:39], v[20:23], v[164:167], v[36:39]
  v_mfma_f32_16x16x32_bf16 v[40:43], v[20:23], v[168:171], v[40:43]
  v_mfma_f32_16x16x32_bf16 v[44:47], v[20:23], v[172:175], v[44:47]
  v_mfma_f32_16x16x32_bf16 v[48:51], v[20:23], v[176:179], v[48:51]
  v_mfma_f32_16x16x32_bf16 v[52:55], v[20:23], v[180:183], v[52:55]
  v_mfma_f32_16x16x32_bf16 v[56:59], v[20:23], v[184:187], v[56:59]
  v_mfma_f32_16x16x32_bf16 v[60:63], v[20:23], v[188:191], v[60:63]
  v_mul_u32_u24 v12, 14336, v3
  v_lshrrev_b32 v13, 3, v2
  v_lshl_add_u32 v12, v13, 6, v12
  v_and_b32 v13, 3, v2
  v_lshl_add_u32 v12, v13, 4, v12
  s_mul_i32 s42, s61, 896
  s_lshl_b32 s43, s60, 7
  s_add_u32 s42, s42, s43
  s_add_u32 s42, s42, 0x1c0000
  v_add_u32 v12, s42, v12
  v_add_f32_dpp v224, v34, v32 row_ror:8 row_mask:0xf bank_mask:0x1
  v_add_f32_dpp v225, v38, v36 row_ror:8 row_mask:0xf bank_mask:0x1
  v_add_f32_dpp v226, v42, v40 row_ror:8 row_mask:0xf bank_mask:0x1
  v_add_f32_dpp v227, v46, v44 row_ror:8 row_mask:0xf bank_mask:0x1
  v_add_f32_dpp v224, v35, v33 row_ror:8 row_mask:0xf bank_mask:0x2
  v_add_f32_dpp v225, v39, v37 row_ror:8 row_mask:0xf bank_mask:0x2
  v_add_f32_dpp v226, v43, v41 row_ror:8 row_mask:0xf bank_mask:0x2
  v_add_f32_dpp v227, v47, v45 row_ror:8 row_mask:0xf bank_mask:0x2
  v_add_f32_dpp v224, v48, v50 row_ror:8 row_mask:0xf bank_mask:0x4
  v_add_f32_dpp v225, v52, v54 row_ror:8 row_mask:0xf bank_mask:0x4
  v_add_f32_dpp v226, v56, v58 row_ror:8 row_mask:0xf bank_mask:0x4
  v_add_f32_dpp v227, v60, v62 row_ror:8 row_mask:0xf bank_mask:0x4
  v_add_f32_dpp v224, v49, v51 row_ror:8 row_mask:0xf bank_mask:0x8
  v_add_f32_dpp v225, v53, v55 row_ror:8 row_mask:0xf bank_mask:0x8
  v_add_f32_dpp v226, v57, v59 row_ror:8 row_mask:0xf bank_mask:0x8
  v_add_f32_dpp v227, v61, v63 row_ror:8 row_mask:0xf bank_mask:0x8
  v_add_f32_dpp v224, v224, v224 row_shl:4 row_mask:0xf bank_mask:0x5
  v_add_f32_dpp v225, v225, v225 row_shl:4 row_mask:0xf bank_mask:0x5
  v_add_f32_dpp v226, v226, v226 row_shl:4 row_mask:0xf bank_mask:0x5
  v_add_f32_dpp v227, v227, v227 row_shl:4 row_mask:0xf bank_mask:0x5
  s_mov_b32 exec_lo, 0x0f0f0f0f
  s_mov_b32 exec_hi, 0x0f0f0f0f
  v_and_or_b32 v224, v224, v15, s96
  v_and_or_b32 v225, v225, v15, s97
  v_and_or_b32 v226, v226, v15, s98
  v_and_or_b32 v227, v227, v15, s99
  global_store_dwordx4 v12, v[224:227], s[40:41] sc1
  s_mov_b64 exec, -1
L_not1:
  s_cmp_eq_u32 s94, 0
  s_cbranch_scc1 L_nowo
  s_mov_b64 s[8:9], s[24:25]
  s_mov_b64 s[12:13], s[24:25]
  s_mov_b32 s10, 0
  s_mov_b32 s14, 0
  s_mov_b64 s[46:47], s[10:11]
  v_mov_b32 v5, 0
  v_mov_b32 v58, 0
L_burst:
  s_bfe_u32 s92, s2, 0x20005
  s_bfe_u32 s93, s2, 0x20003
  s_and_b32 s42, s2, 6
  s_lshl1_add_u32 s93, s42, s93
  v_and_b32 v1, 0x2c, v0
  v_lshlrev_b32 v1, 11, v1
  v_and_b32 v62, 16, v0
  v_lshl_add_u32 v1, v62, 8, v1
  v_and_b32 v63, 3, v0
  v_lshl_add_u32 v1, v63, 4, v1
  s_lshl_b32 s28, s3, 19
  s_lshl_b32 s42, s93, 6
  s_add_u32 s28, s28, s42
  s_add_u32 s29, s28, 0x8000
  s_mov_b32 s26, 0x400000
  s_mov_b32 s27, 0x20000
  s_mov_b32 s48, 0x05040100
  s_mov_b32 s49, 0x07060302
  s_mov_b64 s[100:101], -1
  s_barrier
  buffer_load_dwordx4 v[192:195], v1, s[24:27], s28 offen offset:0
  buffer_load_dwordx4 v[196:199], v1, s[24:27], s28 offen offset:1024
  buffer_load_dwordx4 v[200:203], v1, s[24:27], s29 offen offset:0
  buffer_load_dwordx4 v[204:207], v1, s[24:27], s29 offen offset:1024
  buffer_load_dwordx4 v[208:211], v1, s[24:27], s28 offen offset:2048
  buffer_load_dwordx4 v[212:215], v1, s[24:27], s28 offen offset:3072
  buffer_load_dwordx4 v[216:219], v1, s[24:27], s29 offen offset:2048
  buffer_load_dwordx4 v[220:223], v1, s[24:27], s29 offen offset:3072
  s_add_u32 s28, s28, 0x20000
  s_add_u32 s29, s29, 0x20000
  buffer_load_dwordx4 v[224:227], v1, s[24:27], s28 offen offset:0
  buffer_load_dwordx4 v[228:231], v1, s[24:27], s28 offen offset:1024
  buffer_load_dwordx4 v[232:235], v1, s[24:27], s29 offen offset:0
  buffer_load_dwordx4 v[236:239], v1, s[24:27], s29 offen offset:1024
  buffer_load_dwordx4 v[240:243], v1, s[24:27], s28 offen offset:2048
  buffer_load_dwordx4 v[244:247], v1, s[24:27], s28 offen offset:3072
  buffer_load_dwordx4 v[248:251], v1, s[24:27], s29 offen offset:2048
  buffer_load_dwordx4 v[252:255], v1, s[24:27], s29 offen offset:3072
  s_add_u32 s28, s28, 0x20000
  s_add_u32 s29, s29, 0x20000
  buffer_load_dwordx4 v[96:99], v1, s[24:27], s28 offen offset:0
  buffer_load_dwordx4 v[100:103], v1, s[24:27], s28 offen offset:1024
  buffer_load_dwordx4 v[104:107], v1, s[24:27], s29 offen offset:0
  buffer_load_dwordx4 v[108:111], v1, s[24:27], s29 offen offset:1024
  buffer_load_dwordx4 v[112:115], v1, s[24:27], s28 offen offset:2048
  buffer_load_dwordx4 v[116:119], v1, s[24:27], s28 offen offset:3072
  buffer_load_dwordx4 v[120:123], v1, s[24:27], s29 offen offset:2048
  buffer_load_dwordx4 v[124:127], v1, s[24:27], s29 offen offset:3072
  s_add_u32 s28, s28, 0x20000
  s_add_u32 s29, s29, 0x20000
  buffer_load_dwordx4 v[16:19], v1, s[24:27], s28 offen offset:0
  buffer_load_dwordx4 v[20:23], v1, s[24:27], s28 offen offset:1024
  buffer_load_dwordx4 v[24:27], v1, s[24:27], s29 offen offset:0
  buffer_load_dwordx4 v[28:31], v1, s[24:27], s29 offen offset:1024
  buffer_load_dwordx4 v[32:35], v1, s[24:27], s28 offen offset:2048
  buffer_load_dwordx4 v[36:39], v1, s[24:27], s28 offen offset:3072
  buffer_load_dwordx4 v[48:51], v1, s[24:27], s29 offen offset:2048
  buffer_load_dwordx4 v[52:55], v1, s[24:27], s29 offen offset:3072
  s_lshl_b32 s42, s92, 14
  s_lshl_b32 s43, s3, 11
  s_add_u32 s42, s42, s43
  s_add_u32 s42, s42, 0x40000
  v_lshl_add_u32 v62, v62, 3, s42
  v_and_b32 v63, 0x27, v0
  v_lshl_add_u32 v62, v63, 4, v62
  v_and_b32 v63, 8, v0
  v_lshl_add_u32 v62, v63, 5, v62
  v_bfe_u32 v63, v0, 2, 1
  v_mul_u32_u24 v63, 0xaaaa, v63
  v_add_u32 v63, 0x4444, v63
  s_waitcnt vmcnt(24)
  v_perm_b32 v128, v196, v192, s48
  v_perm_b32 v129, v204, v200, s48
  v_perm_b32 v130, v212, v208, s48
  v_perm_b32 v131, v220, v216, s48
  v_perm_b32 v136, v196, v192, s49
  v_perm_b32 v137, v204, v200, s49
  v_perm_b32 v138, v212, v208, s49
  v_perm_b32 v139, v220, v216, s49
  v_perm_b32 v144, v197, v193, s48
  v_perm_b32 v145, v205, v201, s48
  v_perm_b32 v146, v213, v209, s48
  v_perm_b32 v147, v221, v217, s48
  v_perm_b32 v152, v197, v193, s49
  v_perm_b32 v153, v205, v201, s49
  v_perm_b32 v154, v213, v209, s49
  v_perm_b32 v155, v221, v217, s49
  v_perm_b32 v160, v198, v194, s48
  v_perm_b32 v161, v206, v202, s48
  v_perm_b32 v162, v214, v210, s48
  v_perm_b32 v163, v222, v218, s48
  v_perm_b32 v168, v198, v194, s49
  v_perm_b32 v169, v206, v202, s49
  v_perm_b32 v170, v214, v210, s49
  v_perm_b32 v171, v222, v218, s49
  v_perm_b32 v176, v199, v195, s48
  v_perm_b32 v177, v207, v203, s48
  v_perm_b32 v178, v215, v211, s48
  v_perm_b32 v179, v223, v219, s48
  v_perm_b32 v184, v199, v195, s49
  v_perm_b32 v185, v207, v203, s49
  v_perm_b32 v186, v215, v211, s49
  v_perm_b32 v187, v223, v219, s49
  s_waitcnt vmcnt(16)
  v_perm_b32 v132, v228, v224, s48
  v_perm_b32 v133, v236, v232, s48
  v_perm_b32 v134, v244, v240, s48
  v_perm_b32 v135, v252, v248, s48
  v_perm_b32 v140, v228, v224, s49
  v_perm_b32 v141, v236, v232, s49
  v_perm_b32 v142, v244, v240, s49
  v_perm_b32 v143, v252, v248, s49
  v_perm_b32 v148, v229, v225, s48
  v_perm_b32 v149, v237, v233, s48
  v_perm_b32 v150, v245, v241, s48
  v_perm_b32 v151, v253, v249, s48
  v_perm_b32 v156, v229, v225, s49
  v_perm_b32 v157, v237, v233, s49
  v_perm_b32 v158, v245, v241, s49
  v_perm_b32 v159, v253, v249, s49
  v_perm_b32 v164, v230, v226, s48
  v_perm_b32 v165, v238, v234, s48
  v_perm_b32 v166, v246, v242, s48
  v_perm_b32 v167, v254, v250, s48
  v_perm_b32 v172, v230, v226, s49
  v_perm_b32 v173, v238, v234, s49
  v_perm_b32 v174, v246, v242, s49
  v_perm_b32 v175, v254, v250, s49
  v_perm_b32 v180, v231, v227, s48
  v_perm_b32 v181, v239, v235, s48
  v_perm_b32 v182, v247, v243, s48
  v_perm_b32 v183, v255, v251, s48
  v_perm_b32 v188, v231, v227, s49
  v_perm_b32 v189, v239, v235, s49
  v_perm_b32 v190, v247, v243, s49
  v_perm_b32 v191, v255, v251, s49
  s_waitcnt vmcnt(8)
  v_perm_b32 v192, v100, v96, s48
  v_perm_b32 v193, v108, v104, s48
  v_perm_b32 v194, v116, v112, s48
  v_perm_b32 v195, v124, v120, s48
  v_perm_b32 v200, v100, v96, s49
  v_perm_b32 v201, v108, v104, s49
  v_perm_b32 v202, v116, v112, s49
  v_perm_b32 v203, v124, v120, s49
  v_perm_b32 v208, v101, v97, s48
  v_perm_b32 v209, v109, v105, s48
  v_perm_b32 v210, v117, v113, s48
  v_perm_b32 v211, v125, v121, s48
  v_perm_b32 v216, v101, v97, s49
  v_perm_b32 v217, v109, v105, s49
  v_perm_b32 v218, v117, v113, s49
  v_perm_b32 v219, v125, v121, s49
  v_perm_b32 v224, v102, v98, s48
  v_perm_b32 v225, v110, v106, s48
  v_perm_b32 v226, v118, v114, s48
  v_perm_b32 v227, v126, v122, s48
  v_perm_b32 v232, v102, v98, s49
  v_perm_b32 v233, v110, v106, s49
  v_perm_b32 v234, v118, v114, s49
  v_perm_b32 v235, v126, v122, s49
  v_perm_b32 v240, v103, v99, s48
  v_perm_b32 v241, v111, v107, s48
  v_perm_b32 v242, v119, v115, s48
  v_perm_b32 v243, v127, v123, s48
  v_perm_b32 v248, v103, v99, s49
  v_perm_b32 v249, v111, v107, s49
  v_perm_b32 v250, v119, v115, s49
  v_perm_b32 v251, v127, v123, s49
  s_waitcnt vmcnt(0)
  s_barrier
  v_perm_b32 v196, v20, v16, s48
  v_perm_b32 v197, v28, v24, s48
  v_perm_b32 v198, v36, v32, s48
  v_perm_b32 v199, v52, v48, s48
  v_perm_b32 v204, v20, v16, s49
  v_perm_b32 v205, v28, v24, s49
  v_perm_b32 v206, v36, v32, s49
  v_perm_b32 v207, v52, v48, s49
  v_perm_b32 v212, v21, v17, s48
  v_perm_b32 v213, v29, v25, s48
  v_perm_b32 v214, v37, v33, s48
  v_perm_b32 v215, v53, v49, s48
  v_perm_b32 v220, v21, v17, s49
  v_perm_b32 v221, v29, v25, s49
  v_perm_b32 v222, v37, v33, s49
  v_perm_b32 v223, v53, v49, s49
  v_perm_b32 v228, v22, v18, s48
  v_perm_b32 v229, v30, v26, s48
  v_perm_b32 v230, v38, v34, s48
  v_perm_b32 v231, v54, v50, s48
  v_perm_b32 v236, v22, v18, s49
  v_perm_b32 v237, v30, v26, s49
  v_perm_b32 v238, v38, v34, s49
  v_perm_b32 v239, v54, v50, s49
  v_perm_b32 v244, v23, v19, s48
  v_perm_b32 v245, v31, v27, s48
  v_perm_b32 v246, v39, v35, s48
  v_perm_b32 v247, v55, v51, s48
  v_perm_b32 v252, v23, v19, s49
  v_perm_b32 v253, v31, v27, s49
  v_perm_b32 v254, v39, v35, s49
  v_perm_b32 v255, v55, v51, s49
  s_cmp_lt_u32 s3, 4
  s_cbranch_scc1 L_nobu
L_nowo:
  s_cmp_lg_u32 s7, 0
  s_cbranch_scc1 L_noctl
  s_and_b32 s42, s2, 7
  s_mul_i32 s42, s42, 1280
  s_add_u32 s42, s42, 0x98000
  v_lshl_add_u32 v12, v4, 2, s42
  s_lshr_b32 s43, s2, 3
  s_lshl2_add_u32 s42, s43, s42
  v_mov_b32 v14, s42
  s_mov_b32 s45, 23
  s_cmp_lg_u32 s94, 0
  s_cselect_b32 s61, 0, 0
  s_mov_b32 s55, 262144
  s_mov_b32 exec_hi, 0
L_ctl:
  ds_read_b32 v13, v10 offset:11776
  s_sub_u32 s46, 96, s45
  s_lshr_b32 s46, s46, 1
  s_sub_u32 s46, s46, s61
  s_waitcnt lgkmcnt(0)
  v_readfirstlane_b32 s47, v13
  s_add_u32 s42, s47, s46
  s_xor_b32 s43, s42, s63
  v_mov_b32 v13, s43
  s_mov_b32 exec_lo, 1
  global_store_dword v14, v13, s[40:41]
  s_cmp_ge_u32 s47, 376
  s_cbranch_scc1 L_ctl2
  s_mov_b32 exec_lo, -1
  global_load_dword v11, v12, s[40:41] sc1
  s_sub_u32 s42, s42, 6
  s_waitcnt vmcnt(0)
  v_xor_b32 v11, s63, v11
  v_cmp_gt_u32 vcc, 0x400, v11
  v_subrev_u32 v11, s42, v11
  v_cndmask_b32 v11, 0, v11, vcc
  s_nop 1
  v_add_u32_dpp v11, v11, v11 quad_perm:[1,0,3,2] row_mask:0xf bank_mask:0xf
  s_nop 1
  v_add_u32_dpp v11, v11, v11 quad_perm:[2,3,0,1] row_mask:0xf bank_mask:0xf
  s_nop 1
  v_add_u32_dpp v11, v11, v11 row_half_mirror row_mask:0xf bank_mask:0xf
  s_nop 1
  v_add_u32_dpp v11, v11, v11 row_mirror row_mask:0xf bank_mask:0xf
  s_cmp_lt_u32 s47, 4
  s_cbranch_scc1 L_ctl3
  v_readlane_b32 s43, v11, 0
  v_readlane_b32 s42, v11, 16
  s_add_i32 s42, s43, s42
  s_mul_i32 s42, s42, 8
  s_add_i32 s42, s42, 256
  s_ashr_i32 s42, s42, 9
  s_add_i32 s45, s42, 23
  s_max_i32 s45, s45, 16
  s_min_i32 s45, s45, 32
  v_mov_b32 v13, s45
  ds_write_b32 v10, v13 offset:8720
  s_branch L_ctl3
L_ctl2:
  s_sleep 8
L_ctl3:
  s_sub_u32 s55, s55, 1
  s_cbranch_scc1 L_ctl4
  s_cmp_lt_u32 s47, 384
  s_cbranch_scc1 L_ctl
L_ctl4:
  v_mov_b32 v13, 48
  ds_write_b32 v10, v13 offset:8720
  s_mov_b64 exec, -1
L_noctl:
  s_cmp_lg_u32 s7, 2
  s_cbranch_scc1 L_nopub
  v_lshlrev_b32 v12, 2, v2
  s_mov_b32 s55, 262144
L_sp_m:
  ds_read_b32 v14, v12 offset:8448
  ds_read_b32 v11, v12 offset:8512
  s_waitcnt lgkmcnt(0)
  v_max_u32 v13, v14, v11
  v_cmp_eq_u32 vcc, -1, v13
  s_cbranch_vccz L_sp_m_done
  s_sleep 4
  s_sub_u32 s55, s55, 1
  s_cmp_lg_u32 s55, 0
  s_cbranch_scc1 L_sp_m
L_sp_m_done:
  ds_read_b128 v[104:107], v6 offset:12032
  v_mov_b32 v96, v14
  s_nop 1
  v_max_f32_dpp v96, v96, v96 quad_perm:[1,0,3,2] row_mask:0xf bank_mask:0xf
  s_nop 1
  v_max_f32_dpp v96, v96, v96 quad_perm:[2,3,0,1] row_mask:0xf bank_mask:0xf
  s_nop 1
  v_max_f32_dpp v96, v96, v96 row_half_mirror row_mask:0xf bank_mask:0xf
  s_nop 1
  v_max_f32_dpp v96, v96, v96 row_mirror row_mask:0xf bank_mask:0xf
  v_sub_f32 v13, v14, v96
  v_exp_f32 v13, v13
  v_mov_b32 v97, s63
  v_mov_b32 v99, s63
  v_mul_f32 v98, v13, v11
  s_nop 1
  v_add_f32_dpp v98, v98, v98 quad_perm:[1,0,3,2] row_mask:0xf bank_mask:0xf
  s_nop 1
  v_add_f32_dpp v98, v98, v98 quad_perm:[2,3,0,1] row_mask:0xf bank_mask:0xf
  s_nop 1
  v_add_f32_dpp v98, v98, v98 row_half_mirror row_mask:0xf bank_mask:0xf
  s_nop 1
  v_add_f32_dpp v98, v98, v98 row_mirror row_mask:0xf bank_mask:0xf
  s_lshl_b32 s42, s59, 8
  s_add_u32 s42, s42, 0x80000
  v_and_b32 v11, 0x70, v6
  v_add_u32 v11, s42, v11
  s_mov_b64 exec, 0xff
  s_waitcnt vmcnt(0)
  global_store_dwordx4 v11, v[96:99], s[40:41] sc1
  s_mov_b64 exec, -1
  v_xor_b32 v11, 0x100, v11
  s_mov_b32 s55, 262144
L_sp_p:
  global_load_dwordx4 v[100:103], v11, s[40:41] sc1
  s_waitcnt vmcnt(0)
  v_xor_b32 v13, s63, v101
  v_bitop3_b32 v13, v13, v103, s63 bitop3:0xf6
  v_cmp_ne_u32 vcc, 0, v13
  s_cbranch_vccz L_sp_p_done
  s_sleep 32
  s_sub_u32 s55, s55, 1
  s_cmp_lg_u32 s55, 0
  s_cbranch_scc1 L_sp_p
L_sp_p_done:
  v_max_f32 v97, v96, v100
  v_sub_f32 v96, v96, v97
  v_sub_f32 v100, v100, v97
  v_sub_f32 v14, v14, v97
  v_exp_f32 v96, v96
  v_exp_f32 v100, v100
  v_exp_f32 v14, v14
  v_mul_f32 v98, v96, v98
  v_fmac_f32 v98, v100, v102
  v_rcp_f32 v98, v98
  v_and_b32 v13, 0x3c, v4
  v_mul_f32 v14, v14, v98
  v_min_u32 v14, -2, v14
  ds_write_b32 v12, v14 offset:8576
  ds_read_b32 v14, v13 offset:8576
  s_lshl_b32 s42, s59, 7
  s_add_u32 s42, s42, 0xa0000
  v_lshl_add_u32 v11, v2, 3, s42
  v_xor_b32 v12, 0x80, v11
  s_lshl_b32 s42, s59, 10
  s_add_u32 s42, s42, 0xc0000
  v_add_u32 v9, s42, v6
  v_mov_b32 v97, s63
  s_waitcnt lgkmcnt(0)
  v_mul_f32 v104, v14, v104
  v_mul_f32 v105, v14, v105
  v_mul_f32 v106, v14, v106
  v_mul_f32 v107, v14, v107
  v_and_or_b32 v104, v104, v15, s96
  v_and_or_b32 v105, v105, v15, s97
  v_and_or_b32 v106, v106, v15, s98
  v_and_or_b32 v107, v107, v15, s99
  s_cmp_eq_u32 s94, 0
  s_cbranch_scc1 L_sp_e_done
  s_mov_b32 s55, 262144
L_sp_w:
  ds_read_b32 v13, v10 offset:11776
  s_waitcnt lgkmcnt(0)
  v_readfirstlane_b32 s42, v13
  s_cmp_ge_u32 s42, 260
  s_cbranch_scc1 L_sp_w_done
  s_sleep 16
  s_sub_u32 s55, s55, 1
  s_cmp_lg_u32 s55, 0
  s_cbranch_scc1 L_sp_w
L_sp_w_done:
  s_lshl_b32 s42, s92, 14
  s_add_u32 s42, s42, 0x80004
  v_lshl_add_u32 v14, v6, 4, s42
  s_mov_b32 s55, 262144
L_sp_e:
  global_load_dword v13, v14, s[40:41] sc1
  s_waitcnt vmcnt(0)
  v_cmp_ne_u32 vcc, s63, v13
  s_cbranch_vccz L_sp_e_done
  s_sleep 16
  s_sub_u32 s55, s55, 1
  s_cmp_lg_u32 s55, 0
  s_cbranch_scc1 L_sp_e
L_sp_e_done:
  s_mov_b32 s55, 262144
L_sp_a:
  ds_read_b32 v13, v10 offset:11776
  s_waitcnt lgkmcnt(0)
  v_readfirstlane_b32 s42, v13
  s_cmp_ge_u32 s42, 292
  s_cbranch_scc1 L_sp_a_done
  s_sleep 16
  s_sub_u32 s55, s55, 1
  s_cmp_lg_u32 s55, 0
  s_cbranch_scc1 L_sp_a
L_sp_a_done:
  s_mov_b32 s55, 262144
L_sp_b:
  global_load_dwordx2 v[100:101], v12, s[40:41] sc1
  s_waitcnt vmcnt(0)
  ds_read_b32 v13, v10 offset:11776
  v_readfirstlane_b32 s43, v101
  s_waitcnt lgkmcnt(0)
  v_readfirstlane_b32 s42, v13
  s_cmp_eq_u32 s43, s63
  s_cbranch_scc1 L_give
  s_cmp_ge_u32 s42, 352
  s_cbranch_scc1 L_pass
  s_sleep 2
  s_sub_u32 s55, s55, 1
  s_cmp_lg_u32 s55, 0
  s_cbranch_scc1 L_sp_b
L_pass:
  v_mov_b32 v96, 0
  s_mov_b64 exec, 0xffff
  global_store_dwordx2 v11, v[96:97], s[40:41] sc1
  s_mov_b64 exec, -1
  v_mov_b32 v13, 128
  ds_write_b32 v10, v13 offset:8640
  v_xor_b32 v9, 0x400, v9
  s_mov_b32 s55, 262144
L_sp_c:
  global_load_dwordx2 v[100:101], v12, s[40:41] sc1
  s_waitcnt vmcnt(0)
  v_readfirstlane_b32 s43, v101
  v_readfirstlane_b32 s42, v100
  s_cmp_eq_u32 s43, s63
  s_cbranch_scc1 L_sp_c_done
  s_sleep 2
  s_sub_u32 s55, s55, 1
  s_cmp_lg_u32 s55, 0
  s_cbranch_scc1 L_sp_c
L_sp_c_done:
  s_cmp_eq_u32 s42, 0
  s_cbranch_scc1 L_sp_d_done
  s_mov_b32 s55, 262144
L_sp_d:
  global_load_dwordx4 v[104:107], v9, s[40:41] sc1
  s_waitcnt vmcnt(0)
  v_xor_b32 v104, s96, v104
  v_xor_b32 v105, s97, v105
  v_xor_b32 v106, s98, v106
  v_xor_b32 v107, s99, v107
  v_or3_b32 v13, v104, v105, v106
  v_or_b32 v13, v13, v107
  ds_write_b128 v6, v[104:107] offset:12032
  v_cmp_ne_u32_sdwa vcc, v13, v10 src0_sel:BYTE_0 src1_sel:DWORD
  s_cbranch_vccz L_sp_d_done
  s_sleep 2
  s_sub_u32 s55, s55, 1
  s_cmp_lg_u32 s55, 0
  s_cbranch_scc1 L_sp_d
L_sp_d_done:
  s_add_u32 s42, s42, 128
  v_mov_b32 v13, s42
  ds_write_b32 v10, v13 offset:8644
  s_branch L_nopub
L_give:
  s_sub_i32 s42, 378, s42
  s_mul_i32 s42, s42, 16
  s_ashr_i32 s42, s42, 6
  s_max_i32 s42, s42, 0
  s_min_i32 s42, s42, 16
  v_mov_b32 v96, s42
  s_cmp_eq_u32 s42, 0
  s_cbranch_scc1 L_give0
  global_store_dwordx4 v9, v[104:107], s[40:41] sc1
L_give0:
  s_mov_b64 exec, 0xffff
  global_store_dwordx2 v11, v[96:97], s[40:41] sc1
  s_mov_b64 exec, -1
  s_sub_u32 s42, 128, s42
  v_mov_b32 v12, s42
  v_mov_b32 v13, s42
  ds_write_b64 v10, v[12:13] offset:8640
L_nopub:
  s_cmp_eq_u32 s94, 0
  s_cbranch_scc1 L_hend
  s_cmp_lg_u32 s7, 3
  s_cbranch_scc1 L_nog
  v_and_b32 v12, 7, v4
  v_lshlrev_b32 v8, 2, v12
  v_lshrrev_b32 v13, 5, v4
  v_lshl_add_u32 v8, v13, 1, v8
  v_bfe_u32 v13, v4, 4, 1
  v_add_u32 v8, v8, v13
  s_lshl_b32 s42, s93, 6
  v_lshl_add_u32 v13, v8, 1, s42
  global_load_ushort v96, v13, s[34:35]
  v_lshl_add_u32 v13, s92, 10, v13
  global_load_ushort v97, v13, s[16:17]
  s_lshl4_add_u32 s42, s92, s93
  s_mul_i32 s42, s42, 896
  s_add_u32 s42, s42, 0x1c0000
  v_lshrrev_b32 v13, 3, v4
  v_lshl_add_u32 v12, v13, 7, s42
  v_and_b32 v13, 1, v4
  v_lshl_add_u32 v12, v13, 6, v12
  v_and_b32 v13, 6, v4
  v_lshl_add_u32 v12, v13, 3, v12
  s_mov_b32 s55, 262144
L_sp_z:
  v_mov_b32 v32, s96
  v_mov_b32 v33, s97
  v_mov_b32 v34, s98
  v_mov_b32 v35, s99
  s_mov_b32 exec_hi, 0xffffff
  global_load_dwordx4 v[32:35], v12, s[40:41] offset:0 sc1
  s_mov_b32 exec_hi, -1
  s_waitcnt vmcnt(0)
  v_xor_b32 v32, s96, v32
  v_xor_b32 v33, s97, v33
  v_xor_b32 v34, s98, v34
  v_xor_b32 v35, s99, v35
  v_or3_b32 v13, v32, v33, v34
  v_or_b32 v13, v13, v35
  v_cmp_ne_u32_sdwa vcc, v13, v10 src0_sel:BYTE_0 src1_sel:DWORD
  s_cbranch_vccz L_sp_z_done
  s_sleep 32
  s_sub_u32 s55, s55, 1
  s_cmp_lg_u32 s55, 0
  s_cbranch_scc1 L_sp_z
L_sp_z_done:
  v_lshlrev_b32 v96, 16, v96
  v_lshlrev_b32 v97, 16, v97
  s_nop 0
  v_permlane32_swap_b32 v32, v34
  v_permlane32_swap_b32 v33, v35
  v_add_f32 v32, v32, v34
  v_add_f32 v33, v33, v35
  s_nop 1
  v_permlane16_swap_b32 v32, v33
  v_add_f32 v32, v32, v33
  s_nop 1
  v_add_f32_dpp v32, v32, v32 row_ror:8 row_mask:0xf bank_mask:0xf
  v_cvt_pk_bf16_f32 v32, 0, v32
  v_add_f32 v32, v32, v96
  v_cvt_pk_bf16_f32 v32, 0, v32
  v_mul_f32 v33, 0xbfb8aa3b, v32
  v_exp_f32 v33, v33
  v_lshlrev_b32 v8, 3, v8
  v_add_f32 v33, 1.0, v33
  v_rcp_f32 v33, v33
  s_nop 0
  v_mul_f32 v96, v32, v33
  v_cvt_pk_bf16_f32 v96, 0, v96
  ds_write_b64 v8, v[96:97] offset:4096
L_nog:
  s_cmp_lg_u32 s7, 1
  s_cbranch_scc1 L_nodry
  s_mov_b32 s94, 3
  s_mov_b64 s[100:101], 0
  s_branch L_proj
L_dry:
  s_sub_u32 s94, s94, 1
  s_cmp_eq_u32 s94, 2
  s_cbranch_scc1 L_h1
  s_mov_b64 s[100:101], -1
  s_mov_b64 exec, -1
  s_waitcnt vmcnt(0)
L_nodry:
  s_mov_b32 s55, 262144
L_sp_v:
  ds_read_b32 v13, v10 offset:11776
  s_waitcnt lgkmcnt(0)
  v_readfirstlane_b32 s42, v13
  s_cmp_ge_u32 s42, 384
  s_cbranch_scc1 L_sp_v_done
  s_sleep 16
  s_sub_u32 s55, s55, 1
  s_cmp_lg_u32 s55, 0
  s_cbranch_scc1 L_sp_v
L_sp_v_done:
  s_lshl2_add_u32 s42, s2, s7
  s_cmp_lg_u32 s42, 1023
  s_cbranch_scc1 L_nobump
  s_mov_b32 s55, 262144
L_sp_n:
  ds_read_b32 v13, v10 offset:8640
  s_waitcnt lgkmcnt(0)
  v_cmp_eq_u32 vcc, -1, v13
  s_cbranch_vccz L_sp_n_done
  s_sleep 4
  s_sub_u32 s55, s55, 1
  s_cmp_lg_u32 s55, 0
  s_cbranch_scc1 L_sp_n
L_sp_n_done:
  v_mov_b32 v12, 0x90000
  v_mov_b32 v13, s63
  global_store_dword v12, v13, s[40:41] sc1
L_nobump:
  s_mov_b32 s55, 262144
L_sp_o:
  ds_read_b32 v13, v10 offset:11264
  s_waitcnt lgkmcnt(0)
  v_cmp_gt_u32 vcc, 1, v13
  s_cbranch_vccz L_proj
  s_sleep 1
  s_sub_u32 s55, s55, 1
  s_cmp_lg_u32 s55, 0
  s_cbranch_scc1 L_sp_o
L_proj:
  v_mov_b64 v[40:41], -1
  v_mov_b64 v[42:43], -1
  v_mov_b64 v[44:45], -1
  v_mov_b64 v[46:47], -1
  global_load_dwordx4 v[40:43], v62, s[40:41] offset:0 sc1
  global_load_dwordx4 v[44:47], v62, s[40:41] offset:1024 sc1
  v_mov_b64 v[64:65], 0
  v_mov_b64 v[66:67], 0
  v_mov_b64 v[68:69], 0
  v_mov_b64 v[70:71], 0
  v_mov_b64 v[72:73], 0
  v_mov_b64 v[74:75], 0
  v_mov_b64 v[76:77], 0
  v_mov_b64 v[78:79], 0
  v_mov_b64 v[80:81], 0
  v_mov_b64 v[82:83], 0
  v_mov_b64 v[84:85], 0
  v_mov_b64 v[86:87], 0
  v_mov_b64 v[88:89], 0
  v_mov_b64 v[90:91], 0
  v_mov_b64 v[92:93], 0
  v_mov_b64 v[94:95], 0
  v_and_b32 v26, 3, v0
  v_bfe_u32 v27, v0, 2, 2
  v_lshl_add_u32 v26, v26, 2, v27
  v_bfe_u32 v27, v0, 5, 1
  v_lshl_add_u32 v26, v26, 1, v27
  v_mul_u32_u24 v26, 80, v26
  v_bfe_u32 v27, v0, 4, 1
  v_lshl_add_u32 v26, v27, 2, v26
  v_lshl_add_u32 v26, s3, 3, v26
  v_bfe_u32 v28, v0, 1, 5
  v_mul_u32_u24 v27, 80, v28
  v_and_b32 v29, 1, v0
  v_lshl_add_u32 v27, v29, 5, v27
  s_lshl4_add_u32 s42, s92, s93
  s_lshl_b32 s42, s42, 6
  v_lshl_add_u32 v29, v28, 1, s42
  v_lshlrev_b32 v28, 3, v28
  v_and_b32 v30, 63, v0
  v_lshlrev_b32 v30, 2, v30
  v_mov_b32 v31, 1
  s_mov_b32 s55, 2097152
  s_mov_b64 exec, s[100:101]
L_two:
  s_waitcnt vmcnt(1)
  v_max3_u32 v13, v40, v41, v42
  v_max_u32 v13, v13, v43
  v_cmp_eq_u32 vcc, -1, v13
  s_cbranch_vccz L_h0
  global_load_dwordx4 v[40:43], v62, s[40:41] offset:0 sc1
  s_waitcnt vmcnt(1)
  v_max3_u32 v13, v44, v45, v46
  v_max_u32 v13, v13, v47
  v_cmp_eq_u32 vcc, -1, v13
  s_cbranch_vccz L_h1
  global_load_dwordx4 v[44:47], v62, s[40:41] offset:1024 sc1
  s_sub_u32 s55, s55, 1
  s_cbranch_scc0 L_two
L_h1:
  v_smfmac_f32_16x16x64_bf16 v[64:67], v[44:47], v[192:199], v63
  v_smfmac_f32_16x16x64_bf16 v[80:83], v[44:47], v[224:231], v63
  v_smfmac_f32_16x16x64_bf16 v[68:71], v[44:47], v[200:207], v63
  v_smfmac_f32_16x16x64_bf16 v[84:87], v[44:47], v[232:239], v63
  v_smfmac_f32_16x16x64_bf16 v[72:75], v[44:47], v[208:215], v63
  v_smfmac_f32_16x16x64_bf16 v[88:91], v[44:47], v[240:247], v63
  v_smfmac_f32_16x16x64_bf16 v[76:79], v[44:47], v[216:223], v63
  v_smfmac_f32_16x16x64_bf16 v[92:95], v[44:47], v[248:255], v63
  v_max3_u32 v13, v40, v41, v42
  v_max_u32 v13, v13, v43
  v_cmp_eq_u32 vcc, -1, v13
  s_cbranch_vccz L_f0
L_t0:
  global_load_dwordx4 v[40:43], v62, s[40:41] offset:0 sc1
  s_sub_u32 s55, s55, 1
  s_cbranch_scc1 L_f0
  s_waitcnt vmcnt(1)
  v_max3_u32 v13, v40, v41, v42
  v_max_u32 v13, v13, v43
  v_cmp_eq_u32 vcc, -1, v13
  s_cbranch_vccnz L_t0
L_f0:
  v_smfmac_f32_16x16x64_bf16 v[64:67], v[40:43], v[128:135], v63
  v_smfmac_f32_16x16x64_bf16 v[80:83], v[40:43], v[160:167], v63
  v_smfmac_f32_16x16x64_bf16 v[68:71], v[40:43], v[136:143], v63
  v_smfmac_f32_16x16x64_bf16 v[84:87], v[40:43], v[168:175], v63
  v_add_f32_dpp v96, v66, v64 row_ror:8 row_mask:0xf bank_mask:0x1
  v_add_f32_dpp v96, v67, v65 row_ror:8 row_mask:0xf bank_mask:0x2
  v_smfmac_f32_16x16x64_bf16 v[72:75], v[40:43], v[144:151], v63
  v_add_f32_dpp v96, v80, v82 row_ror:8 row_mask:0xf bank_mask:0x4
  v_add_f32_dpp v96, v81, v83 row_ror:8 row_mask:0xf bank_mask:0x8
  v_smfmac_f32_16x16x64_bf16 v[88:91], v[40:43], v[176:183], v63
  v_add_f32_dpp v97, v70, v68 row_ror:8 row_mask:0xf bank_mask:0x1
  v_add_f32_dpp v97, v71, v69 row_ror:8 row_mask:0xf bank_mask:0x2
  v_smfmac_f32_16x16x64_bf16 v[76:79], v[40:43], v[152:159], v63
  v_add_f32_dpp v97, v84, v86 row_ror:8 row_mask:0xf bank_mask:0x4
  v_add_f32_dpp v97, v85, v87 row_ror:8 row_mask:0xf bank_mask:0x8
  v_smfmac_f32_16x16x64_bf16 v[92:95], v[40:43], v[184:191], v63
  v_add_f32_dpp v98, v74, v72 row_ror:8 row_mask:0xf bank_mask:0x1
  v_add_f32_dpp v98, v75, v73 row_ror:8 row_mask:0xf bank_mask:0x2
  s_branch L_fold
L_h0:
  v_smfmac_f32_16x16x64_bf16 v[64:67], v[40:43], v[128:135], v63
  v_smfmac_f32_16x16x64_bf16 v[80:83], v[40:43], v[160:167], v63
  v_smfmac_f32_16x16x64_bf16 v[68:71], v[40:43], v[136:143], v63
  v_smfmac_f32_16x16x64_bf16 v[84:87], v[40:43], v[168:175], v63
  v_smfmac_f32_16x16x64_bf16 v[72:75], v[40:43], v[144:151], v63
  v_smfmac_f32_16x16x64_bf16 v[88:91], v[40:43], v[176:183], v63
  v_smfmac_f32_16x16x64_bf16 v[76:79], v[40:43], v[152:159], v63
  v_smfmac_f32_16x16x64_bf16 v[92:95], v[40:43], v[184:191], v63
  v_max3_u32 v13, v44, v45, v46
  v_max_u32 v13, v13, v47
  v_cmp_eq_u32 vcc, -1, v13
  s_cbranch_vccz L_f1
L_t1:
  global_load_dwordx4 v[44:47], v62, s[40:41] offset:1024 sc1
  s_sub_u32 s55, s55, 1
  s_cbranch_scc1 L_f1
  s_waitcnt vmcnt(1)
  v_max3_u32 v13, v44, v45, v46
  v_max_u32 v13, v13, v47
  v_cmp_eq_u32 vcc, -1, v13
  s_cbranch_vccnz L_t1
L_f1:
  v_smfmac_f32_16x16x64_bf16 v[64:67], v[44:47], v[192:199], v63
  v_smfmac_f32_16x16x64_bf16 v[80:83], v[44:47], v[224:231], v63
  v_smfmac_f32_16x16x64_bf16 v[68:71], v[44:47], v[200:207], v63
  v_smfmac_f32_16x16x64_bf16 v[84:87], v[44:47], v[232:239], v63
  v_add_f32_dpp v96, v66, v64 row_ror:8 row_mask:0xf bank_mask:0x1
  v_add_f32_dpp v96, v67, v65 row_ror:8 row_mask:0xf bank_mask:0x2
  v_smfmac_f32_16x16x64_bf16 v[72:75], v[44:47], v[208:215], v63
  v_add_f32_dpp v96, v80, v82 row_ror:8 row_mask:0xf bank_mask:0x4
  v_add_f32_dpp v96, v81, v83 row_ror:8 row_mask:0xf bank_mask:0x8
  v_smfmac_f32_16x16x64_bf16 v[88:91], v[44:47], v[240:247], v63
  v_add_f32_dpp v97, v70, v68 row_ror:8 row_mask:0xf bank_mask:0x1
  v_add_f32_dpp v97, v71, v69 row_ror:8 row_mask:0xf bank_mask:0x2
  v_smfmac_f32_16x16x64_bf16 v[76:79], v[44:47], v[216:223], v63
  v_add_f32_dpp v97, v84, v86 row_ror:8 row_mask:0xf bank_mask:0x4
  v_add_f32_dpp v97, v85, v87 row_ror:8 row_mask:0xf bank_mask:0x8
  v_smfmac_f32_16x16x64_bf16 v[92:95], v[44:47], v[248:255], v63
  v_add_f32_dpp v98, v74, v72 row_ror:8 row_mask:0xf bank_mask:0x1
  v_add_f32_dpp v98, v75, v73 row_ror:8 row_mask:0xf bank_mask:0x2
L_fold:
  v_add_f32_dpp v100, v96, v96 row_shl:4 row_mask:0xf bank_mask:0x5
  v_add_f32_dpp v101, v97, v97 row_shl:4 row_mask:0xf bank_mask:0x5
  v_add_f32_dpp v98, v88, v90 row_ror:8 row_mask:0xf bank_mask:0x4
  v_add_f32_dpp v98, v89, v91 row_ror:8 row_mask:0xf bank_mask:0x8
  v_add_f32_dpp v99, v78, v76 row_ror:8 row_mask:0xf bank_mask:0x1
  v_add_f32_dpp v99, v79, v77 row_ror:8 row_mask:0xf bank_mask:0x2
  v_add_f32_dpp v99, v92, v94 row_ror:8 row_mask:0xf bank_mask:0x4
  v_add_f32_dpp v99, v93, v95 row_ror:8 row_mask:0xf bank_mask:0x8
  v_add_f32_dpp v100, v98, v98 row_shr:4 row_mask:0xf bank_mask:0xa
  s_nop 0
  v_add_f32_dpp v101, v99, v99 row_shr:4 row_mask:0xf bank_mask:0xa
  s_nop 1
  v_permlane32_swap_b32 v100, v101
  v_add_f32 v100, v100, v101
  ds_write_b32 v26, v100 offset:0
  ds_add_rtn_u32 v31, v30, v31 offset:11520
  ds_read_b128 v[104:107], v27 offset:0
  ds_read_b128 v[108:111], v27 offset:16
  ds_read_b64 v[102:103], v28 offset:4096
  s_waitcnt lgkmcnt(2)
  v_pk_add_f32 v[104:105], v[104:105], v[106:107]
  s_waitcnt lgkmcnt(1)
  v_pk_add_f32 v[108:109], v[108:109], v[110:111]
  v_pk_add_f32 v[104:105], v[104:105], v[108:109]
  v_add_f32 v96, v104, v105
  s_waitcnt lgkmcnt(0)
  s_nop 0
  v_add_f32_dpp v96, v96, v96 quad_perm:[1,0,3,2] row_mask:0xf bank_mask:0xf
  v_cmpx_eq_u32 vcc, 7, v31
  v_cvt_pk_bf16_f32 v96, 0, v96
  v_mul_f32 v96, v96, v102
  v_cvt_pk_bf16_f32 v96, 0, v96
  v_add_f32 v96, v96, v103
  v_cvt_pk_bf16_f32 v96, v96, 0
  global_store_short v29, v96, s[36:37]
  s_cmp_gt_u32 s94, 1
  s_cbranch_scc1 L_dry
L_hend:
L_end:
  s_endpgm
.section .rodata,"a"
.p2align 6
.amdhsa_kernel recurrent_scan__mha_block_cached__mixer_channel_mlp__decode_kernel
  .amdhsa_next_free_vgpr 256
  .amdhsa_next_free_sgpr 102
  .amdhsa_accum_offset 256
  .amdhsa_group_segment_fixed_size 0
  .amdhsa_kernarg_size 104
  .amdhsa_user_sgpr_count 2
  .amdhsa_user_sgpr_kernarg_segment_ptr 1
  .amdhsa_system_sgpr_workgroup_id_x 1
  .amdhsa_float_denorm_mode_32 3
.end_amdhsa_kernel
```
